```python
import torch

def _softmax(x, axis=-1):
    return torch.softmax(x, dim=axis)
def _gelu(x):
    return torch.nn.functional.gelu(x, approximate="tanh")
def _silu(x):
    return torch.nn.functional.silu(x)
def _sigmoid(x):
    return torch.sigmoid(x)
def _layernorm(x, axis=-1, eps=1e-5):
    m = x.mean(dim=axis, keepdim=True)
    v = x.var(dim=axis, keepdim=True, unbiased=False)
    return (x - m) / torch.sqrt(v + eps)
def _scatter_add(tgt, idx, src, axis=0):
    return tgt.clone().index_add_(axis, idx, src)
def _segment_sum(src, seg, n):
    out = torch.zeros((n,) + src.shape[1:], dtype=src.dtype)
    return out.index_add_(0, seg, src)
def _pad(x, pw):
    flat = tuple(v for pair in reversed(pw) for v in pair)
    return torch.nn.functional.pad(x, flat)

kernel_name = 'concat_heads__grouped_kv_mqa__linear_attn_block__prompt'

def setup_inputs():

    _w = (lambda a: (lambda t: t.to(torch.bfloat16) if t.is_floating_point() else t)(torch.as_tensor(a)))
    def _A_setup():
        B, S, D, H = 1, 2048, 512, 32
        Dh = D // H
        return {
            "x": _w((lambda *s: torch.randn(*s, dtype=torch.bfloat16) * 0.05)(B, S, D)),
            "wq": _w((lambda *s: torch.randn(*s, dtype=torch.bfloat16) * 1.6)(D, H * Dh)),
            "wk": _w((lambda *s: torch.randn(*s, dtype=torch.bfloat16) * 1.6)(D, Dh)),
            "wv": _w((lambda *s: torch.randn(*s, dtype=torch.bfloat16) * 0.05)(D, Dh)),
            "wo": _w((lambda *s: torch.randn(*s, dtype=torch.bfloat16) * 0.05)(H * Dh, D)),
        }
    _A_in = _A_setup()

    def _B_setup():
        B, S, D = 1, 2048, 512
        return {
            "x": _w((lambda *s: torch.randn(*s, dtype=torch.bfloat16) * 0.05)(B, S, D)),
            "wqkv": _w((lambda *s: torch.randn(*s, dtype=torch.bfloat16) * 0.8)(D, 3 * D)),
            "wo": _w((lambda *s: torch.randn(*s, dtype=torch.bfloat16) * 0.05)(D, D)),
        }
    _B_in = _B_setup()

    return {
        "A_x": _A_in["x"],
        "A_wq": _A_in["wq"],
        "A_wk": _A_in["wk"],
        "A_wv": _A_in["wv"],
        "A_wo": _A_in["wo"],
        "B_x": _B_in["x"],
        "B_wqkv": _B_in["wqkv"],
        "B_wo": _B_in["wo"],
    }

def reference(A_x, A_wq, A_wk, A_wv, A_wo, B_x, B_wqkv, B_wo):
    def _A_ref(x, wq, wk, wv, wo):
        B, S, D = x.shape
        H = 32
        Dh = D // H
        q = (lambda x, *d: x.permute(*d))((x @ wq).reshape(B, S, H, Dh), 0, 2, 1, 3)
        k = x @ wk
        v = x @ wv
        scores = torch.einsum("bhqd,bkd->bhqk", q, k) * (Dh ** -0.5)
        p = _softmax(scores, axis=-1)
        o = torch.einsum("bhqk,bkd->bhqd", p, v)
        return (lambda x, *d: x.permute(*d))(o, 0, 2, 1, 3).reshape(B, S, H * Dh) @ wo

    def _B_ref(x, wqkv, wo):
        B, S, D = x.shape
        H = 32; Dh = D // H
        qkv = (lambda x, *d: x.permute(*d))((x @ wqkv).reshape(B, S, 3, H, Dh), 2, 0, 3, 1, 4)
        q, k, v = qkv[0], qkv[1], qkv[2]
        phi = lambda t: torch.where(t > 0, t + 1, torch.exp(t)) + 1e-6
        pq, pk = phi(q), phi(k)
        kv = torch.einsum("bhsd,bhse->bhde", pk, v)
        z = torch.einsum("bhsd->bhd", pk)
        num = torch.einsum("bhqd,bhde->bhqe", pq, kv)
        den = torch.einsum("bhqd,bhd->bhq", pq, z)[..., None] + 1e-6
        o = num / den
        return (lambda x, *d: x.permute(*d))(o, 0, 2, 1, 3).reshape(B, S, D) @ wo

    a = _A_ref(A_x, A_wq, A_wk, A_wv, A_wo)
    b = _B_ref(B_x, B_wqkv, B_wo)
    return torch.concatenate([a, b], axis=-1)
```

```asm
; @launch grid=(256,1,1) block=(512,1,1) lds=163840
.amdgcn_target "amdgcn-amd-amdhsa--gfx950"
.text
.globl concat_heads__grouped_kv_mqa__linear_attn_block__prompt_kernel
.p2align 8
.type concat_heads__grouped_kv_mqa__linear_attn_block__prompt_kernel,@function
concat_heads__grouped_kv_mqa__linear_attn_block__prompt_kernel:
    s_cmpk_ge_u32 s2, 256
    s_cbranch_scc1 L_end
    s_load_dwordx16 s[8:23], s[0:1], 0
    s_load_dwordx2 s[26:27], s[0:1], 80
    s_getpc_b64 s[4:5]
L_pc:
    s_lshr_b32 s31, s2, 3
    v_lshl_add_u32 v23, v0, 5, s31
    v_lshlrev_b32 v23, 7, v23
    s_and_b32 s33, s2, 7
    s_lshl_b32 s29, s33, 5
    s_add_u32 s31, s31, s29
    v_cmp_gt_u32 vcc, L_last-L_pc, v23
    s_and_b64 exec, exec, vcc
    s_cbranch_execz L_p_1
    global_load_dword v18, v23, s[4:5]
    s_mov_b64 exec, -1
L_p_1:
    s_mov_b64 exec, -1
    s_load_dwordx2 s[24:25], s[0:1], 64
    v_lshrrev_b32 v1, 6, v0
    v_and_b32 v0, 63, v0
    v_readfirstlane_b32 s28, v1
    s_lshr_b32 s36, s2, 6
    s_lshr_b32 s29, s31, 3
    s_and_b32 s30, s31, 7
    s_lshl_b32 s36, s36, 1
    s_add_u32 s34, s36, s30
    s_and_b32 s34, s34, 7
    s_mov_b32 s35, 0
    s_and_b32 s52, s28, 3
    s_lshr_b32 s50, s52, 1
    s_and_b32 s51, s28, 1
    v_mov_b32 v1, 0
    v_lshlrev_b32 v4, 4, v0
    s_cmp_ge_u32 s28, 4
    s_cselect_b32 s36, 11, 3
    s_cselect_b32 s37, 1, 13
    s_lshl_b32 s38, s52, 2
    s_add_u32 s38, s38, 163584
    v_min_u32 v9, s36, v0
    v_add_u32 v9, s37, v9
    v_and_b32 v9, 15, v9
    v_lshl_add_u32 v9, v9, 4, s38
    ds_write_b32 v9, v1
    v_lshrrev_b32 v8, 3, v0
    v_lshlrev_b32 v2, 10, v8
    v_and_b32 v9, 7, v0
    v_lshrrev_b32 v10, 4, v0
    v_xor_b32 v9, v9, v10
    v_lshl_add_u32 v2, v9, 4, v2
    s_lshl_b32 s36, s28, 2
    s_add_u32 s36, s36, 163584
    v_mov_b32 v5, s36
    s_and_b32 s36, s36, -16
    v_and_b32 v9, 3, v0
    v_lshl_add_u32 v6, v9, 2, s36
    v_bfe_u32 v8, v0, 2, 3
    v_lshlrev_b32 v9, 4, v9
    v_lshrrev_b32 v10, 5, v0
    v_lshl_add_u32 v9, v10, 6, v9
    v_lshl_add_u32 v3, v8, 10, v9
    s_cmp_ge_u32 s28, 4
    s_cbranch_scc1 L_roleB
    v_xor_b32 v10, 64, v2
    v_add_u32 v10, 8192, v10
    s_and_b32 s37, s30, 6
    s_lshl_b32 s42, s29, 16
    s_lshl_b32 s38, s37, 13
    s_add_u32 s42, s42, s38
    s_lshl_b32 s43, s28, 14
    s_lshl_b32 s38, s37, 10
    s_add_u32 s43, s43, s38
    s_lshl_b32 s44, s28, 12
    s_lshl_b32 s45, s28, 1
    s_add_u32 s45, s45, s34
    s_mov_b32 s35, 7
    s_waitcnt lgkmcnt(0)
    s_bitcmp1_b32 s30, 0
    s_cselect_b32 s12, s14, s12
    s_cselect_b32 s13, s15, s13
    s_add_u32 s36, s45, 0
    s_and_b32 s36, s36, 7
    s_lshl_b32 s37, s36, 7
    s_add_u32 s37, s37, s42
    s_add_u32 s38, s8, s37
    s_addc_u32 s39, s9, 0
    s_lshl_b32 s36, s36, 11
    s_add_u32 s40, s12, s36
    s_addc_u32 s41, s13, 0
    s_add_u32 m0, s43, 0
    s_nop 0
    global_load_lds_dwordx4 v2, s[38:39]
    s_add_u32 m0, s43, 1024
    s_nop 0
    global_load_lds_dwordx4 v10, s[38:39]
    s_add_u32 m0, s44, 131072
    s_nop 0
    global_load_lds_dwordx4 v4, s[40:41]
    global_load_lds_dwordx4 v4, s[40:41] offset:1024
    s_getpc_b64 s[0:1]
    s_lshl_b32 s36, s52, 2
    s_add_u32 m0, s36, 163808
    s_mov_b64 exec, 1
    global_load_lds_dword v1, s[0:1]
    s_mov_b64 exec, -1
    s_add_u32 s36, s45, 1
    s_and_b32 s36, s36, 7
    s_lshl_b32 s37, s36, 7
    s_add_u32 s37, s37, s42
    s_add_u32 s38, s8, s37
    s_addc_u32 s39, s9, 0
    s_lshl_b32 s36, s36, 11
    s_add_u32 s40, s12, s36
    s_addc_u32 s41, s13, 0
    s_add_u32 m0, s43, 8192
    s_nop 0
    global_load_lds_dwordx4 v2, s[38:39]
    s_add_u32 m0, s43, 9216
    s_nop 0
    global_load_lds_dwordx4 v10, s[38:39]
    s_add_u32 m0, s44, 133120
    s_nop 0
    global_load_lds_dwordx4 v4, s[40:41]
    global_load_lds_dwordx4 v4, s[40:41] offset:1024
    s_lshl_b32 s36, s52, 2
    s_add_u32 m0, s36, 163792
    s_mov_b64 exec, 1
    global_load_lds_dword v1, s[0:1]
    s_mov_b64 exec, -1
    s_barrier
    s_branch L_bodyA
L_roleB:
    s_lshl_b32 s36, s31, 8
    s_add_u32 s36, s36, 65536
    v_lshl_add_u32 v24, v0, 2, s36
    s_mul_i32 s36, s31, 640
    s_add_u32 s36, s36, 131072
    v_add_u32 v101, s36, v4
    v_cmp_eq_u32 vcc, 32, v0
    v_mov_b32 v112, 0x3f803f80
    s_nop 0
    v_cndmask_b32 v112, 0, v112, vcc
    v_mov_b32 v113, v112
    v_mov_b32 v114, v112
    v_mov_b32 v115, v112
    v_add_u32 v80, 0, v3
    v_add_u32 v81, 8192, v3
    v_add_u32 v82, 16384, v3
    v_add_u32 v83, 24576, v3
    s_lshl_b32 s36, s51, 6
    v_xor_b32 v20, s36, v2
    s_add_u32 s36, s30, 2
    s_and_b32 s36, s36, 6
    s_add_u32 s36, s36, s51
    s_lshl_b32 s96, s36, 10
    s_lshl_b32 s36, s36, 13
    v_add_u32 v84, s36, v20
    s_add_u32 s36, s30, 4
    s_and_b32 s36, s36, 6
    s_add_u32 s36, s36, s51
    s_lshl_b32 s97, s36, 10
    s_lshl_b32 s36, s36, 13
    v_add_u32 v85, s36, v20
    s_add_u32 s36, s30, 6
    s_and_b32 s36, s36, 6
    s_add_u32 s36, s36, s51
    s_lshl_b32 s98, s36, 10
    s_lshl_b32 s36, s36, 13
    v_add_u32 v86, s36, v20
    s_add_u32 s36, s33, 1
    s_lshl_b32 s36, s36, 3
    v_add_u32 v92, s36, v0
    v_and_b32 v92, 63, v92
    v_lshlrev_b32 v92, 7, v92
    v_add_u32 v92, 32768, v92
    s_lshl_b32 s99, s51, 12
    s_lshl_b32 s100, s29, 16
    s_lshl_b32 s60, s30, 7
    s_lshl_b32 s36, s51, 15
    s_add_u32 s60, s60, s36
    s_waitcnt lgkmcnt(0)
    s_cmp_lg_u32 s28, 4
    s_cbranch_scc1 L_b_36
    global_store_dword v24, v1, s[26:27] sc1
    s_mov_b32 exec_lo, -1
    s_mov_b32 exec_hi, 0xff
    global_store_dwordx4 v101, v[112:115], s[26:27] sc1
    s_mov_b64 exec, -1
L_b_36:
    s_lshr_b32 s36, s31, 2
    s_lshl_b32 s36, s36, 7
    s_and_b32 s37, s31, 3
    s_lshl_b32 s37, s37, 2
    s_add_u32 s36, s36, s37
    s_add_u32 s36, s36, 32768
    s_add_u32 s14, s26, s36
    s_addc_u32 s15, s27, 0
    s_load_dword s53, s[14:15], 0
    s_load_dword s32, s[26:27], 0
    s_getpc_b64 s[0:1]
    s_barrier
    s_cmp_lt_u32 s28, 6
    s_cbranch_scc1 L_b_37
    s_mov_b32 s42, 0
    s_mov_b32 s101, 2
    s_lshl_b32 s43, s52, 2
L_ld_41:
    s_add_u32 s36, s34, s42
    s_and_b32 s36, s36, 7
    s_lshl_b32 s37, s36, 16
    s_add_u32 s37, s37, s60
    s_add_u32 s38, s10, s37
    s_addc_u32 s39, s11, 0
    s_lshl_b32 s36, s36, 7
    s_add_u32 s36, s36, s100
    s_add_u32 s40, s8, s36
    s_addc_u32 s41, s9, 0
    s_add_u32 m0, s99, 65536
    s_nop 0
    global_load_lds_dwordx4 v80, s[38:39]
    s_add_u32 m0, s99, 66560
    s_nop 0
    global_load_lds_dwordx4 v81, s[38:39]
    s_add_u32 m0, s99, 67584
    s_nop 0
    global_load_lds_dwordx4 v82, s[38:39]
    s_add_u32 m0, s99, 68608
    s_nop 0
    global_load_lds_dwordx4 v83, s[38:39]
    s_mov_b32 m0, s96
    s_add_u32 s96, s96, 8192
    global_load_lds_dwordx4 v84, s[40:41]
    s_mov_b32 m0, s97
    s_add_u32 s97, s97, 8192
    global_load_lds_dwordx4 v85, s[40:41]
    s_mov_b32 m0, s98
    s_add_u32 s98, s98, 8192
    global_load_lds_dwordx4 v86, s[40:41]
    s_add_u32 m0, s43, 163664
    s_mov_b64 exec, 1
    global_load_lds_dword v1, s[0:1]
    s_mov_b64 exec, -1
    s_add_u32 s43, s43, 16
    s_add_u32 s99, s99, 8192
    s_add_u32 s42, s42, 1
    s_waitcnt vmcnt(48)
    s_cmp_lt_u32 s42, s101
    s_cbranch_scc1 L_ld_41
    s_cmp_lg_u32 s101, 8
    s_cbranch_scc1 L_b_38
    s_cmp_lg_u32 s28, 6
    s_cbranch_scc1 L_b_39
    s_mov_b64 exec, 0xffff
    s_mov_b32 s46, 0
L_poll_42:
    global_load_dwordx4 v[88:91], v92, s[26:27] sc1
    s_add_u32 s46, s46, 1
    s_waitcnt vmcnt(0)
    v_cmp_ne_u32 vcc, s32, v88
    v_cmp_ne_u32 s[48:49], s32, v89
    s_or_b64 vcc, vcc, s[48:49]
    v_cmp_ne_u32 s[48:49], s32, v90
    s_or_b64 vcc, vcc, s[48:49]
    v_cmp_ne_u32 s[48:49], s32, v91
    s_or_b64 vcc, vcc, s[48:49]
    s_cmp_eq_u64 vcc, 0
    s_cbranch_scc1 L_polld_43
    s_cmp_lt_u32 s46, 200000
    s_cbranch_scc1 L_poll_42
L_polld_43:
    s_mov_b64 exec, -1
    s_branch L_b_39
L_b_37:
    s_cmp_lg_u32 s28, 4
    s_cbranch_scc1 L_b_38
    s_setprio 3
    v_mov_b32 v102, 163664
    v_and_b32 v96, 15, v0
    v_and_b32 v97, 3, v0
    v_bfe_u32 v98, v0, 2, 1
    v_lshl_add_u32 v97, v98, 3, v97
    v_bfe_u32 v98, v0, 3, 1
    v_lshl_add_u32 v97, v98, 2, v97
    s_bitcmp1_b32 s30, 0
    s_cselect_b64 vcc, -1, 0
    s_cselect_b32 s44, 1.0, 0x3eb8aa3b
    v_cndmask_b32 v96, v96, v97, vcc
    v_lshrrev_b32 v98, 4, v0
    v_lshrrev_b32 v97, 1, v96
    v_xor_b32 v97, v97, v98
    v_lshlrev_b32 v96, 7, v96
    v_lshl_add_u32 v96, v97, 4, v96
    s_and_b32 s36, s30, 6
    s_lshl_b32 s36, s36, 10
    v_add_u32 v96, s36, v96
    v_xor_b32 v97, 64, v96
    v_bfe_u32 v99, v0, 2, 2
    v_lshl_add_u32 v99, v98, 3, v99
    v_lshlrev_b32 v99, 5, v99
    v_and_b32 v100, 3, v0
    v_lshl_add_u32 v99, v100, 3, v99
    v_add_u32 v99, 131072, v99
    v_add_u32 v21, 192, v6
    s_bitcmp1_b32 s30, 0
    s_cbranch_scc1 L_kvv_44
    s_mov_b32 s46, 0
L_sb_46:
    ds_read_b32 v20, v21 offset:16
    s_waitcnt lgkmcnt(0)
    v_cmp_gt_u32 vcc, 1, v20
    s_add_u32 s46, s46, 1
    s_cmp_eq_u64 vcc, 0
    s_cbranch_scc1 L_sbd_47
    s_cmp_lt_u32 s46, 1600000
    s_cbranch_scc1 L_sb_46
L_sbd_47:
    ds_read_b128 v[128:131], v96 offset:0
    ds_read_b64_tr_b16 v[160:161], v99 offset:0
    ds_read_b64_tr_b16 v[162:163], v99 offset:128
    ds_read_b128 v[132:135], v97 offset:0
    ds_read_b64_tr_b16 v[164:165], v99 offset:1024
    ds_read_b64_tr_b16 v[166:167], v99 offset:1152
    ds_read_b128 v[136:139], v96 offset:16384
    ds_read_b64_tr_b16 v[168:169], v99 offset:4096
    ds_read_b64_tr_b16 v[170:171], v99 offset:4224
    ds_read_b128 v[140:143], v97 offset:16384
    ds_read_b64_tr_b16 v[172:173], v99 offset:5120
    ds_read_b64_tr_b16 v[174:175], v99 offset:5248
    ds_read_b128 v[144:147], v96 offset:32768
    ds_read_b64_tr_b16 v[176:177], v99 offset:8192
    ds_read_b64_tr_b16 v[178:179], v99 offset:8320
    s_waitcnt lgkmcnt(12)
    v_mfma_f32_16x16x32_bf16 v[104:107], v[160:163], v[128:131], 0
    ds_read_b128 v[148:151], v97 offset:32768
    ds_read_b64_tr_b16 v[180:181], v99 offset:9216
    ds_read_b64_tr_b16 v[182:183], v99 offset:9344
    s_waitcnt lgkmcnt(12)
    v_mfma_f32_16x16x32_bf16 v[104:107], v[164:167], v[132:135], v[104:107]
    ds_read_b128 v[152:155], v96 offset:49152
    ds_read_b64_tr_b16 v[184:185], v99 offset:12288
    ds_read_b64_tr_b16 v[186:187], v99 offset:12416
    s_waitcnt lgkmcnt(12)
    v_mfma_f32_16x16x32_bf16 v[104:107], v[168:171], v[136:139], v[104:107]
    ds_read_b128 v[156:159], v97 offset:49152
    ds_read_b64_tr_b16 v[188:189], v99 offset:13312
    ds_read_b64_tr_b16 v[190:191], v99 offset:13440
    s_waitcnt lgkmcnt(12)
    v_mfma_f32_16x16x32_bf16 v[104:107], v[172:175], v[140:143], v[104:107]
    s_mov_b32 s46, 0
L_sb_48:
    ds_read_b32 v20, v21 offset:0
    s_waitcnt lgkmcnt(0)
    v_cmp_gt_u32 vcc, 1, v20
    s_add_u32 s46, s46, 1
    s_cmp_eq_u64 vcc, 0
    s_cbranch_scc1 L_sbd_49
    s_cmp_lt_u32 s46, 1600000
    s_cbranch_scc1 L_sb_48
L_sbd_49:
    ds_read_b128 v[128:131], v96 offset:8192
    ds_read_b64_tr_b16 v[160:161], v99 offset:2048
    ds_read_b64_tr_b16 v[162:163], v99 offset:2176
    v_mfma_f32_16x16x32_bf16 v[104:107], v[176:179], v[144:147], v[104:107]
    ds_read_b128 v[132:135], v97 offset:8192
    ds_read_b64_tr_b16 v[164:165], v99 offset:3072
    ds_read_b64_tr_b16 v[166:167], v99 offset:3200
    v_mfma_f32_16x16x32_bf16 v[104:107], v[180:183], v[148:151], v[104:107]
    ds_read_b128 v[136:139], v96 offset:24576
    ds_read_b64_tr_b16 v[168:169], v99 offset:6144
    ds_read_b64_tr_b16 v[170:171], v99 offset:6272
    v_mfma_f32_16x16x32_bf16 v[104:107], v[184:187], v[152:155], v[104:107]
    ds_read_b128 v[140:143], v97 offset:24576
    ds_read_b64_tr_b16 v[172:173], v99 offset:7168
    ds_read_b64_tr_b16 v[174:175], v99 offset:7296
    v_mfma_f32_16x16x32_bf16 v[104:107], v[188:191], v[156:159], v[104:107]
    ds_read_b128 v[144:147], v96 offset:40960
    ds_read_b64_tr_b16 v[176:177], v99 offset:10240
    ds_read_b64_tr_b16 v[178:179], v99 offset:10368
    s_waitcnt lgkmcnt(12)
    v_mfma_f32_16x16x32_bf16 v[104:107], v[160:163], v[128:131], v[104:107]
    ds_read_b128 v[148:151], v97 offset:40960
    ds_read_b64_tr_b16 v[180:181], v99 offset:11264
    ds_read_b64_tr_b16 v[182:183], v99 offset:11392
    s_waitcnt lgkmcnt(12)
    v_mfma_f32_16x16x32_bf16 v[104:107], v[164:167], v[132:135], v[104:107]
    ds_read_b128 v[152:155], v96 offset:57344
    ds_read_b64_tr_b16 v[184:185], v99 offset:14336
    ds_read_b64_tr_b16 v[186:187], v99 offset:14464
    s_waitcnt lgkmcnt(12)
    v_mfma_f32_16x16x32_bf16 v[104:107], v[168:171], v[136:139], v[104:107]
    ds_read_b128 v[156:159], v97 offset:57344
    ds_read_b64_tr_b16 v[188:189], v99 offset:15360
    ds_read_b64_tr_b16 v[190:191], v99 offset:15488
    s_waitcnt lgkmcnt(12)
    v_mfma_f32_16x16x32_bf16 v[104:107], v[172:175], v[140:143], v[104:107]
    s_waitcnt lgkmcnt(9)
    v_mfma_f32_16x16x32_bf16 v[104:107], v[176:179], v[144:147], v[104:107]
    s_waitcnt lgkmcnt(6)
    v_mfma_f32_16x16x32_bf16 v[104:107], v[180:183], v[148:151], v[104:107]
    s_waitcnt lgkmcnt(3)
    v_mfma_f32_16x16x32_bf16 v[104:107], v[184:187], v[152:155], v[104:107]
    s_waitcnt lgkmcnt(0)
    v_mfma_f32_16x16x32_bf16 v[104:107], v[188:191], v[156:159], v[104:107]
    s_branch L_kvd_45
L_kvv_44:
    s_mov_b32 s46, 0
L_sb_50:
    ds_read_b32 v20, v21 offset:16
    s_waitcnt lgkmcnt(0)
    v_cmp_gt_u32 vcc, 1, v20
    s_add_u32 s46, s46, 1
    s_cmp_eq_u64 vcc, 0
    s_cbranch_scc1 L_sbd_51
    s_cmp_lt_u32 s46, 1600000
    s_cbranch_scc1 L_sb_50
L_sbd_51:
    ds_read_b128 v[128:131], v96 offset:0
    ds_read_b64_tr_b16 v[160:161], v99 offset:0
    ds_read_b64_tr_b16 v[162:163], v99 offset:128
    ds_read_b128 v[132:135], v97 offset:0
    ds_read_b64_tr_b16 v[164:165], v99 offset:1024
    ds_read_b64_tr_b16 v[166:167], v99 offset:1152
    ds_read_b128 v[136:139], v96 offset:16384
    ds_read_b64_tr_b16 v[168:169], v99 offset:4096
    ds_read_b64_tr_b16 v[170:171], v99 offset:4224
    ds_read_b128 v[140:143], v97 offset:16384
    ds_read_b64_tr_b16 v[172:173], v99 offset:5120
    ds_read_b64_tr_b16 v[174:175], v99 offset:5248
    ds_read_b128 v[144:147], v96 offset:32768
    ds_read_b64_tr_b16 v[176:177], v99 offset:8192
    ds_read_b64_tr_b16 v[178:179], v99 offset:8320
    s_waitcnt lgkmcnt(12)
    v_mfma_f32_16x16x32_bf16 v[104:107], v[128:131], v[160:163], 0
    ds_read_b128 v[148:151], v97 offset:32768
    ds_read_b64_tr_b16 v[180:181], v99 offset:9216
    ds_read_b64_tr_b16 v[182:183], v99 offset:9344
    s_waitcnt lgkmcnt(12)
    v_mfma_f32_16x16x32_bf16 v[104:107], v[132:135], v[164:167], v[104:107]
    ds_read_b128 v[152:155], v96 offset:49152
    ds_read_b64_tr_b16 v[184:185], v99 offset:12288
    ds_read_b64_tr_b16 v[186:187], v99 offset:12416
    s_waitcnt lgkmcnt(12)
    v_mfma_f32_16x16x32_bf16 v[104:107], v[136:139], v[168:171], v[104:107]
    ds_read_b128 v[156:159], v97 offset:49152
    ds_read_b64_tr_b16 v[188:189], v99 offset:13312
    ds_read_b64_tr_b16 v[190:191], v99 offset:13440
    s_waitcnt lgkmcnt(12)
    v_mfma_f32_16x16x32_bf16 v[104:107], v[140:143], v[172:175], v[104:107]
    s_mov_b32 s46, 0
L_sb_52:
    ds_read_b32 v20, v21 offset:0
    s_waitcnt lgkmcnt(0)
    v_cmp_gt_u32 vcc, 1, v20
    s_add_u32 s46, s46, 1
    s_cmp_eq_u64 vcc, 0
    s_cbranch_scc1 L_sbd_53
    s_cmp_lt_u32 s46, 1600000
    s_cbranch_scc1 L_sb_52
L_sbd_53:
    ds_read_b128 v[128:131], v96 offset:8192
    ds_read_b64_tr_b16 v[160:161], v99 offset:2048
    ds_read_b64_tr_b16 v[162:163], v99 offset:2176
    v_mfma_f32_16x16x32_bf16 v[104:107], v[144:147], v[176:179], v[104:107]
    ds_read_b128 v[132:135], v97 offset:8192
    ds_read_b64_tr_b16 v[164:165], v99 offset:3072
    ds_read_b64_tr_b16 v[166:167], v99 offset:3200
    v_mfma_f32_16x16x32_bf16 v[104:107], v[148:151], v[180:183], v[104:107]
    ds_read_b128 v[136:139], v96 offset:24576
    ds_read_b64_tr_b16 v[168:169], v99 offset:6144
    ds_read_b64_tr_b16 v[170:171], v99 offset:6272
    v_mfma_f32_16x16x32_bf16 v[104:107], v[152:155], v[184:187], v[104:107]
    ds_read_b128 v[140:143], v97 offset:24576
    ds_read_b64_tr_b16 v[172:173], v99 offset:7168
    ds_read_b64_tr_b16 v[174:175], v99 offset:7296
    v_mfma_f32_16x16x32_bf16 v[104:107], v[156:159], v[188:191], v[104:107]
    ds_read_b128 v[144:147], v96 offset:40960
    ds_read_b64_tr_b16 v[176:177], v99 offset:10240
    ds_read_b64_tr_b16 v[178:179], v99 offset:10368
    s_waitcnt lgkmcnt(12)
    v_mfma_f32_16x16x32_bf16 v[104:107], v[128:131], v[160:163], v[104:107]
    ds_read_b128 v[148:151], v97 offset:40960
    ds_read_b64_tr_b16 v[180:181], v99 offset:11264
    ds_read_b64_tr_b16 v[182:183], v99 offset:11392
    s_waitcnt lgkmcnt(12)
    v_mfma_f32_16x16x32_bf16 v[104:107], v[132:135], v[164:167], v[104:107]
    ds_read_b128 v[152:155], v96 offset:57344
    ds_read_b64_tr_b16 v[184:185], v99 offset:14336
    ds_read_b64_tr_b16 v[186:187], v99 offset:14464
    s_waitcnt lgkmcnt(12)
    v_mfma_f32_16x16x32_bf16 v[104:107], v[136:139], v[168:171], v[104:107]
    ds_read_b128 v[156:159], v97 offset:57344
    ds_read_b64_tr_b16 v[188:189], v99 offset:15360
    ds_read_b64_tr_b16 v[190:191], v99 offset:15488
    s_waitcnt lgkmcnt(12)
    v_mfma_f32_16x16x32_bf16 v[104:107], v[140:143], v[172:175], v[104:107]
    s_waitcnt lgkmcnt(9)
    v_mfma_f32_16x16x32_bf16 v[104:107], v[144:147], v[176:179], v[104:107]
    s_waitcnt lgkmcnt(6)
    v_mfma_f32_16x16x32_bf16 v[104:107], v[148:151], v[180:183], v[104:107]
    s_waitcnt lgkmcnt(3)
    v_mfma_f32_16x16x32_bf16 v[104:107], v[152:155], v[184:187], v[104:107]
    s_waitcnt lgkmcnt(0)
    v_mfma_f32_16x16x32_bf16 v[104:107], v[156:159], v[188:191], v[104:107]
L_kvd_45:
    s_nop 7
    v_pk_mul_f32 v[104:105], v[104:105], s[44:45] op_sel_hi:[1,0]
    v_pk_mul_f32 v[106:107], v[106:107], s[44:45] op_sel_hi:[1,0]
    v_cvt_pk_bf16_f32 v108, v104, v105
    v_cvt_pk_bf16_f32 v109, v106, v107
    s_nop 1
    v_permlane32_swap_b32 v108, v110
    v_permlane32_swap_b32 v109, v111
    s_mov_b32 exec_hi, 0
    global_store_dwordx4 v101, v[108:111], s[26:27] sc1
    s_mov_b32 exec_hi, -1
    ds_write_b32 v102, v102 offset:112
    s_sub_u32 s53, s32, s53
    s_add_u32 s53, s53, 0x2f1b4c6d
    s_setprio 0
    s_waitcnt vmcnt(0)
    s_atomic_add s53, s[14:15], 0 glc
L_b_38:
    v_mov_b32 v26, v2
    v_xor_b32 v27, 64, v2
    v_add_u32 v27, 8192, v27
    v_mul_u32_u24 v240, 3072, v8
    v_add_u32 v240, v240, v9
    v_mov_b32 v28, v3
    v_add_u32 v241, 24576, v240
    v_add_u32 v29, 8192, v3
    v_add_u32 v242, 49152, v240
    v_add_u32 v30, 16384, v3
    v_add_u32 v243, 73728, v240
    v_add_u32 v31, 24576, v3
    v_and_b32 v20, 31, v0
    v_lshlrev_b32 v21, 7, v20
    s_lshl_b32 s36, s50, 12
    v_add_u32 v21, s36, v21
    v_bfe_u32 v20, v0, 1, 3
    v_lshrrev_b32 v22, 5, v0
    v_xor_b32 v20, v20, v22
    v_lshl_add_u32 v244, v20, 4, v21
    v_xor_b32 v245, 32, v244
    v_xor_b32 v246, 64, v244
    v_xor_b32 v247, 0x60, v244
    v_bfe_u32 v20, v0, 2, 2
    v_lshlrev_b32 v20, 6, v20
    v_bfe_u32 v21, v0, 4, 1
    v_lshl_add_u32 v20, v21, 5, v20
    v_and_b32 v21, 3, v0
    v_lshl_add_u32 v20, v21, 3, v20
    v_lshrrev_b32 v21, 5, v0
    v_lshl_add_u32 v20, v21, 10, v20
    s_lshl_b32 s36, s51, 9
    s_add_u32 s36, s36, 65536
    v_add_u32 v248, s36, v20
    v_bfe_u32 v20, v0, 2, 2
    v_lshlrev_b32 v20, 6, v20
    v_lshrrev_b32 v21, 5, v0
    v_lshl_add_u32 v20, v21, 8, v20
    v_and_b32 v22, 1, v0
    v_lshl_add_u32 v20, v22, 5, v20
    v_bfe_u32 v22, v0, 1, 1
    v_lshl_add_u32 v20, v22, 3, v20
    v_bfe_u32 v22, v0, 4, 1
    v_lshl_add_u32 v20, v22, 4, v20
    s_mul_i32 s36, s51, 0
    s_add_u32 s36, s36, 0
    v_add_u32 v8, s36, v20
    s_lshl_b32 s36, s52, 12
    s_add_u32 s36, s36, 131072
    v_add_u32 v9, s36, v4
    v_xor_b32 v3, 4096, v9
    v_lshrrev_b32 v20, 3, v0
    v_lshlrev_b32 v20, 11, v20
    v_and_b32 v21, 7, v0
    v_lshl_add_u32 v2, v21, 4, v20
    s_lshl_b32 s36, s29, 1
    s_add_u32 s36, s36, s50
    s_lshl_b32 s37, s36, 16
    s_lshl_b32 s38, s30, 1
    s_add_u32 s38, s38, s51
    s_lshl_b32 s39, s30, 7
    s_add_u32 s37, s37, s39
    s_lshl_b32 s39, s51, 15
    s_add_u32 s37, s37, s39
    s_add_u32 s37, s37, 0
    s_add_u32 s56, s24, s37
    s_addc_u32 s57, s25, 0
    s_lshl_b32 s36, s36, 15
    s_lshl_b32 s38, s38, 11
    s_add_u32 s38, s38, s36
    s_add_u32 s38, s38, 3145728
    v_add_u32 v13, s38, v4
    s_lshl_b32 s37, s51, 14
    s_add_u32 s36, s36, s37
    s_add_u32 s36, s36, 1048576
    s_add_u32 s54, s26, s36
    s_addc_u32 s55, s27, 0
    s_lshl_b32 s36, s52, 13
    s_add_u32 s36, s36, 65536
    v_lshrrev_b32 v20, 5, v0
    v_lshlrev_b32 v20, 2, v20
    v_and_b32 v21, 7, v0
    v_xor_b32 v20, v20, v21
    v_and_b32 v22, 31, v0
    v_lshl_add_u32 v22, v22, 8, s36
    v_lshl_add_u32 v9, v20, 4, v22
    v_xor_b32 v14, 16, v9
    v_xor_b32 v15, 32, v9
    v_xor_b32 v17, 48, v9
    s_lshl_b32 s36, s50, 14
    s_lshl_b32 s37, s51, 12
    s_add_u32 s36, s36, s37
    s_add_u32 s36, s36, 65536
    v_lshrrev_b32 v20, 3, v0
    v_lshlrev_b32 v21, 1, v21
    v_xor_b32 v21, v21, v20
    v_lshl_add_u32 v20, v20, 8, s36
    v_lshl_add_u32 v3, v21, 4, v20
    v_xor_b32 v24, 16, v3
    s_lshl_b32 s4, s52, 11
    s_lshl_b32 s5, s52, 12
    s_lshl_b32 s6, s29, 16
    s_lshl_b32 s36, s52, 14
    s_add_u32 s6, s6, s36
    s_mul_i32 s7, s51, 98304
    s_lshl_b32 s36, s30, 7
    s_add_u32 s7, s7, s36
    s_mov_b32 s36, 0x358637bd
    s_mov_b32 s37, 0x358637bd
    s_mov_b32 s38, 0x3f803f80
    s_mov_b32 s39, 0x3f803f80
    v_mov_b64 v[32:33], s[36:37]
    v_mov_b64 v[64:65], s[36:37]
    v_mov_b64 v[224:225], s[38:39]
    v_mov_b64 v[34:35], s[36:37]
    v_mov_b64 v[66:67], s[36:37]
    v_mov_b64 v[226:227], s[38:39]
    v_mov_b64 v[36:37], s[36:37]
    v_mov_b64 v[68:69], s[36:37]
    v_mov_b64 v[38:39], s[36:37]
    v_mov_b64 v[70:71], s[36:37]
    v_mov_b64 v[40:41], s[36:37]
    v_mov_b64 v[72:73], s[36:37]
    v_mov_b64 v[42:43], s[36:37]
    v_mov_b64 v[74:75], s[36:37]
    v_mov_b64 v[44:45], s[36:37]
    v_mov_b64 v[76:77], s[36:37]
    v_mov_b64 v[46:47], s[36:37]
    v_mov_b64 v[78:79], s[36:37]
    v_mov_b32 v18, 0xb5c1a2a0
    v_mov_b64 v[252:253], -1
    v_mov_b64 v[254:255], -1
    v_mov_b32 v25, 63
    v_mul_u32_u24 v250, 12288, v0
    v_lshlrev_b32 v251, 12, v0
    v_lshlrev_b32 v10, 7, v0
    s_lshl_b32 s36, s52, 10
    s_add_u32 s36, s36, 151552
    v_add_u32 v11, s36, v4
    v_xor_b32 v228, 2048, v11
    v_and_b32 v20, 15, v0
    v_bfe_u32 v21, v0, 4, 1
    v_lshlrev_b32 v22, 11, v21
    v_lshl_add_u32 v229, v20, 2, v22
    v_lshrrev_b32 v22, 5, v0
    v_lshl_add_u32 v230, v22, 8, v229
    s_lshl_b32 s36, s50, 9
    v_add_u32 v230, s36, v230
    v_and_b32 v20, 31, v0
    v_min_u32 v20, 16, v20
    v_lshlrev_b32 v20, 6, v20
    v_lshl_add_u32 v12, v22, 4, v20
    s_add_u32 s62, s26, 32768
    s_addc_u32 s63, s27, 0
    s_waitcnt lgkmcnt(0)
    s_add_u32 s32, s32, 0x2f1b4c6d
    v_mov_b32 v7, s32
    s_cmp_lt_u32 s28, 6
    s_cbranch_scc1 L_b_39
    v_mov_b32 v21, 163776
    s_mov_b32 s46, 0
L_sb_54:
    ds_read_b32 v20, v21 offset:0
    s_waitcnt lgkmcnt(0)
    v_cmp_gt_u32 vcc, 1, v20
    s_add_u32 s46, s46, 1
    s_cmp_eq_u64 vcc, 0
    s_cbranch_scc1 L_sbd_55
    s_cmp_lt_u32 s46, 1600000
    s_cbranch_scc1 L_sb_54
L_sbd_55:
    s_mov_b32 s101, 8
    s_branch L_ld_41
L_b_39:
    s_barrier
    s_mov_b32 s35, 8
    s_lshl_b32 s36, s52, 11
    s_add_u32 s62, s62, s36
    s_addc_u32 s63, s63, 0
    s_lshl_b32 s36, s30, 12
    s_add_u32 s36, s36, 393216
    s_add_u32 s8, s26, s36
    s_addc_u32 s9, s27, 0
    s_lshl_b32 s36, s29, 1
    s_add_u32 s36, s36, s50
    s_lshl_b32 s36, s36, 1
    s_lshr_b32 s37, s30, 2
    s_add_u32 s37, s37, s36
    s_mul_i32 s37, s37, 1280
    s_add_u32 s37, s37, 131648
    s_add_u32 s10, s26, s37
    s_addc_u32 s11, s27, 0
    s_add_u32 s36, s36, s51
    s_mul_i32 s36, s36, 1280
    s_add_u32 s36, s36, 131648
    s_add_u32 s12, s26, s36
    s_addc_u32 s13, s27, 0
    s_barrier
    s_branch L_bodyB
L_bodyA:
    v_and_b32 v20, 31, v0
    v_lshlrev_b32 v21, 7, v20
    s_lshl_b32 s36, s50, 12
    v_add_u32 v21, s36, v21
    v_bfe_u32 v20, v0, 1, 3
    v_lshrrev_b32 v22, 5, v0
    v_xor_b32 v20, v20, v22
    v_lshl_add_u32 v248, v20, 4, v21
    v_xor_b32 v249, 32, v248
    v_xor_b32 v250, 64, v248
    v_xor_b32 v251, 0x60, v248
    v_bfe_u32 v20, v0, 2, 2
    v_lshlrev_b32 v20, 6, v20
    v_bfe_u32 v21, v0, 4, 1
    v_lshl_add_u32 v20, v21, 5, v20
    v_and_b32 v21, 3, v0
    v_lshl_add_u32 v20, v21, 3, v20
    v_lshrrev_b32 v21, 5, v0
    v_lshl_add_u32 v20, v21, 10, v20
    s_lshl_b32 s36, s51, 9
    s_add_u32 s36, s36, 65536
    v_add_u32 v252, s36, v20
    v_mov_b64 v[64:65], 0
    v_mov_b64 v[66:67], 0
    v_mov_b64 v[68:69], 0
    v_mov_b64 v[70:71], 0
    v_mov_b64 v[72:73], 0
    v_mov_b64 v[74:75], 0
    v_mov_b64 v[76:77], 0
    v_mov_b64 v[78:79], 0
    v_mov_b64 v[80:81], 0
    v_mov_b64 v[82:83], 0
    v_mov_b64 v[84:85], 0
    v_mov_b64 v[86:87], 0
    v_mov_b64 v[88:89], 0
    v_mov_b64 v[90:91], 0
    v_mov_b64 v[92:93], 0
    v_mov_b64 v[94:95], 0
    v_mov_b64 v[96:97], 0
    v_mov_b64 v[98:99], 0
    v_mov_b64 v[100:101], 0
    v_mov_b64 v[102:103], 0
    v_mov_b64 v[104:105], 0
    v_mov_b64 v[106:107], 0
    v_mov_b64 v[108:109], 0
    v_mov_b64 v[110:111], 0
    v_mov_b64 v[112:113], 0
    v_mov_b64 v[114:115], 0
    v_mov_b64 v[116:117], 0
    v_mov_b64 v[118:119], 0
    v_mov_b64 v[120:121], 0
    v_mov_b64 v[122:123], 0
    v_mov_b64 v[124:125], 0
    v_mov_b64 v[126:127], 0
    v_mov_b64 v[236:237], 0
    v_mov_b64 v[238:239], 0
    v_and_b32 v20, 15, v0
    v_lshlrev_b32 v20, 4, v20
    v_lshrrev_b32 v21, 5, v0
    v_lshl_add_u32 v20, v21, 8, v20
    v_bfe_u32 v21, v0, 4, 1
    v_mul_u32_u24 v22, 1280, v21
    v_add_u32 v11, v20, v22
    v_cmp_eq_u32 vcc, 0, v21
    v_and_b32 v22, 11, v0
    v_min_u32 v22, 1, v22
    v_lshlrev_b32 v22, 4, v22
    v_add_u32 v22, 512, v22
    v_mov_b32 v10, 0xdddd
    v_cndmask_b32 v12, v22, v20, vcc
    s_lshl_b32 s36, s28, 9
    s_add_u32 s36, s36, 147456
    v_lshl_add_u32 v48, v0, 2, s36
    v_xor_b32 v49, 512, v48
    v_and_b32 v60, 1, v0
    v_mul_u32_u24 v60, 12, v60
    v_add_u32 v60, 4, v60
    v_xor_b32 v60, v60, v5
    v_mov_b32 v61, 30
    v_and_b32 v51, 4, v0
    v_add_u32 v52, 80, v6
    v_or_b32 v53, 8, v52
    v_and_b32 v54, 3, v0
    v_cmp_eq_u32 vcc, 0, v54
    s_nop 1
    v_cndmask_b32 v54, v53, v52, vcc
    v_lshl_add_u32 v51, v51, 4, v6
    s_lshl_b32 s36, s50, 15
    v_add_u32 v14, s36, v4
    v_bfe_u32 v20, v0, 2, 2
    v_lshlrev_b32 v20, 6, v20
    v_lshrrev_b32 v21, 5, v0
    v_lshl_add_u32 v20, v21, 8, v20
    v_and_b32 v22, 1, v0
    v_lshl_add_u32 v20, v22, 5, v20
    v_bfe_u32 v22, v0, 1, 1
    v_lshl_add_u32 v20, v22, 3, v20
    v_bfe_u32 v22, v0, 4, 1
    v_lshl_add_u32 v20, v22, 4, v20
    s_mul_i32 s36, s51, 512
    s_add_u32 s36, s36, 65536
    v_add_u32 v8, s36, v20
    s_lshl_b32 s36, s52, 12
    s_add_u32 s36, s36, 131072
    v_add_u32 v9, s36, v4
    v_xor_b32 v3, 4096, v9
    v_lshrrev_b32 v20, 3, v0
    v_lshlrev_b32 v20, 11, v20
    v_and_b32 v21, 7, v0
    v_lshl_add_u32 v2, v21, 4, v20
    s_lshl_b32 s36, s29, 1
    s_add_u32 s36, s36, s50
    s_lshl_b32 s37, s36, 16
    s_lshl_b32 s38, s30, 1
    s_add_u32 s38, s38, s51
    s_lshl_b32 s39, s30, 7
    s_add_u32 s37, s37, s39
    s_lshl_b32 s39, s51, 15
    s_add_u32 s37, s37, s39
    s_add_u32 s37, s37, 1024
    s_add_u32 s56, s24, s37
    s_addc_u32 s57, s25, 0
    s_lshl_b32 s36, s36, 15
    s_lshl_b32 s38, s38, 11
    s_add_u32 s38, s38, s36
    s_add_u32 s38, s38, 1048576
    v_add_u32 v13, s38, v4
    s_lshl_b32 s37, s51, 14
    s_add_u32 s36, s36, s37
    s_add_u32 s36, s36, 1048576
    s_add_u32 s54, s26, s36
    s_addc_u32 s55, s27, 0
    s_lshl_b32 s36, s50, 12
    s_add_u32 s36, s36, 151552
    v_lshrrev_b32 v20, 5, v0
    v_lshlrev_b32 v20, 1, v20
    s_lshl_b32 s37, s51, 2
    v_add_u32 v20, s37, v20
    v_and_b32 v21, 7, v0
    v_xor_b32 v20, v20, v21
    v_and_b32 v22, 31, v0
    v_lshl_add_u32 v22, v22, 7, s36
    v_lshl_add_u32 v57, v20, 4, v22
    v_xor_b32 v58, 16, v57
    v_lshrrev_b32 v20, 3, v0
    v_xor_b32 v21, v21, v20
    s_lshl_b32 s37, s51, 11
    s_add_u32 s36, s36, s37
    v_lshl_add_u32 v20, v20, 7, s36
    v_lshl_add_u32 v59, v21, 4, v20
    s_add_u32 s6, s33, 1
    s_and_b32 s6, s6, 7
    s_lshl_b32 s6, s6, 3
    s_add_u32 s6, s6, s51
    s_mul_i32 s6, s6, 2560
    s_add_u32 s6, s6, 131072
    s_add_u32 s8, s26, s6
    s_addc_u32 s9, s27, 0
    s_add_u32 s6, s6, 5120
    s_add_u32 s10, s26, s6
    s_addc_u32 s11, s27, 0
    s_add_u32 s6, s6, 5120
    s_add_u32 s12, s26, s6
    s_addc_u32 s13, s27, 0
    s_add_u32 s6, s6, 5120
    s_branch L_attn0_stub
L_warmed:
    s_mov_b32 s46, 0
L_sb_2:
    ds_read_b32 v20, v52 offset:128
    s_waitcnt lgkmcnt(0)
    v_cmp_gt_u32 vcc, 1, v20
    s_add_u32 s46, s46, 1
    s_cmp_eq_u64 vcc, 0
    s_cbranch_scc1 L_sbd_3
    s_sleep 1
    s_cmp_lt_u32 s46, 1600000
    s_cbranch_scc1 L_sb_2
L_sbd_3:
    s_mov_b32 s46, 0
L_sb_4:
    ds_read_b32 v20, v53 offset:0
    s_waitcnt lgkmcnt(0)
    v_cmp_gt_u32 vcc, 1, v20
    s_add_u32 s46, s46, 1
    s_cmp_eq_u64 vcc, 0
    s_cbranch_scc1 L_sbd_5
    s_cmp_lt_u32 s46, 1600000
    s_cbranch_scc1 L_sb_4
L_sbd_5:
    ds_read_b128 v[128:131], v248 offset:0
    ds_read_b64_tr_b16 v[160:161], v252 offset:0
    ds_read_b64_tr_b16 v[162:163], v252 offset:256
    ds_read_b128 v[132:135], v249 offset:0
    ds_read_b64_tr_b16 v[164:165], v252 offset:2048
    ds_read_b64_tr_b16 v[166:167], v252 offset:2304
    ds_read_b128 v[136:139], v250 offset:0
    ds_read_b64_tr_b16 v[168:169], v252 offset:4096
    ds_read_b64_tr_b16 v[170:171], v252 offset:4352
    ds_read_b128 v[140:143], v251 offset:0
    ds_read_b64_tr_b16 v[172:173], v252 offset:6144
    ds_read_b64_tr_b16 v[174:175], v252 offset:6400
    ds_read_b32 v20, v53 offset:16
    s_waitcnt lgkmcnt(10)
    v_mfma_f32_32x32x16_bf16 v[32:47], v[160:163], v[128:131], 0
    s_waitcnt lgkmcnt(7)
    v_mfma_f32_32x32x16_bf16 v[32:47], v[164:167], v[132:135], v[32:47]
    s_waitcnt lgkmcnt(0)
    v_cmp_gt_u32 vcc, 1, v20
    s_cmp_eq_u64 vcc, 0
    s_cbranch_scc1 L_a_6
    v_mfma_f32_32x32x16_bf16 v[32:47], v[168:171], v[136:139], v[32:47]
    v_mfma_f32_32x32x16_bf16 v[32:47], v[172:175], v[140:143], v[32:47]
    s_mov_b32 s46, 0
L_sb_8:
    ds_read_b32 v20, v53 offset:16
    s_waitcnt lgkmcnt(0)
    v_cmp_gt_u32 vcc, 1, v20
    s_add_u32 s46, s46, 1
    s_cmp_eq_u64 vcc, 0
    s_cbranch_scc1 L_sbd_9
    s_cmp_lt_u32 s46, 1600000
    s_cbranch_scc1 L_sb_8
L_sbd_9:
    ds_read_b128 v[144:147], v248 offset:8192
    ds_read_b64_tr_b16 v[176:177], v252 offset:8192
    ds_read_b64_tr_b16 v[178:179], v252 offset:8448
    ds_read_b128 v[148:151], v249 offset:8192
    ds_read_b64_tr_b16 v[180:181], v252 offset:10240
    ds_read_b64_tr_b16 v[182:183], v252 offset:10496
    ds_read_b128 v[152:155], v250 offset:8192
    ds_read_b64_tr_b16 v[184:185], v252 offset:12288
    ds_read_b64_tr_b16 v[186:187], v252 offset:12544
    ds_read_b128 v[156:159], v251 offset:8192
    ds_read_b64_tr_b16 v[188:189], v252 offset:14336
    ds_read_b64_tr_b16 v[190:191], v252 offset:14592
    s_branch L_a_7
L_a_6:
    ds_read_b128 v[144:147], v248 offset:8192
    ds_read_b64_tr_b16 v[176:177], v252 offset:8192
    ds_read_b64_tr_b16 v[178:179], v252 offset:8448
    ds_read_b128 v[148:151], v249 offset:8192
    ds_read_b64_tr_b16 v[180:181], v252 offset:10240
    ds_read_b64_tr_b16 v[182:183], v252 offset:10496
    v_mfma_f32_32x32x16_bf16 v[32:47], v[168:171], v[136:139], v[32:47]
    ds_read_b128 v[152:155], v250 offset:8192
    ds_read_b64_tr_b16 v[184:185], v252 offset:12288
    ds_read_b64_tr_b16 v[186:187], v252 offset:12544
    ds_read_b128 v[156:159], v251 offset:8192
    ds_read_b64_tr_b16 v[188:189], v252 offset:14336
    ds_read_b64_tr_b16 v[190:191], v252 offset:14592
    v_mfma_f32_32x32x16_bf16 v[32:47], v[172:175], v[140:143], v[32:47]
L_a_7:
    ds_read_b32 v20, v53 offset:48
    s_waitcnt lgkmcnt(10)
    v_mfma_f32_32x32x16_bf16 v[32:47], v[176:179], v[144:147], v[32:47]
    s_waitcnt lgkmcnt(7)
    v_mfma_f32_32x32x16_bf16 v[32:47], v[180:183], v[148:151], v[32:47]
    s_waitcnt lgkmcnt(0)
    v_cmp_gt_u32 vcc, 1, v20
    s_cmp_eq_u64 vcc, 0
    s_cbranch_scc1 L_a_10
    v_mfma_f32_32x32x16_bf16 v[32:47], v[184:187], v[152:155], v[32:47]
    v_mfma_f32_32x32x16_bf16 v[32:47], v[188:191], v[156:159], v[32:47]
    s_mov_b32 s46, 0
L_sb_12:
    ds_read_b32 v20, v53 offset:48
    s_waitcnt lgkmcnt(0)
    v_cmp_gt_u32 vcc, 1, v20
    s_add_u32 s46, s46, 1
    s_cmp_eq_u64 vcc, 0
    s_cbranch_scc1 L_sbd_13
    s_cmp_lt_u32 s46, 1600000
    s_cbranch_scc1 L_sb_12
L_sbd_13:
    ds_read_b128 v[128:131], v248 offset:16384
    ds_read_b64_tr_b16 v[160:161], v252 offset:16384
    ds_read_b64_tr_b16 v[162:163], v252 offset:16640
    ds_read_b128 v[132:135], v249 offset:16384
    ds_read_b64_tr_b16 v[164:165], v252 offset:18432
    ds_read_b64_tr_b16 v[166:167], v252 offset:18688
    ds_read_b128 v[136:139], v250 offset:16384
    ds_read_b64_tr_b16 v[168:169], v252 offset:20480
    ds_read_b64_tr_b16 v[170:171], v252 offset:20736
    ds_read_b128 v[140:143], v251 offset:16384
    ds_read_b64_tr_b16 v[172:173], v252 offset:22528
    ds_read_b64_tr_b16 v[174:175], v252 offset:22784
    s_branch L_a_11
L_a_10:
    ds_read_b128 v[128:131], v248 offset:16384
    ds_read_b64_tr_b16 v[160:161], v252 offset:16384
    ds_read_b64_tr_b16 v[162:163], v252 offset:16640
    ds_read_b128 v[132:135], v249 offset:16384
    ds_read_b64_tr_b16 v[164:165], v252 offset:18432
    ds_read_b64_tr_b16 v[166:167], v252 offset:18688
    v_mfma_f32_32x32x16_bf16 v[32:47], v[184:187], v[152:155], v[32:47]
    ds_read_b128 v[136:139], v250 offset:16384
    ds_read_b64_tr_b16 v[168:169], v252 offset:20480
    ds_read_b64_tr_b16 v[170:171], v252 offset:20736
    ds_read_b128 v[140:143], v251 offset:16384
    ds_read_b64_tr_b16 v[172:173], v252 offset:22528
    ds_read_b64_tr_b16 v[174:175], v252 offset:22784
    v_mfma_f32_32x32x16_bf16 v[32:47], v[188:191], v[156:159], v[32:47]
L_a_11:
    ds_read_b128 v[144:147], v248 offset:24576
    ds_read_b64_tr_b16 v[176:177], v252 offset:24576
    ds_read_b64_tr_b16 v[178:179], v252 offset:24832
    s_waitcnt lgkmcnt(12)
    v_mfma_f32_32x32x16_bf16 v[32:47], v[160:163], v[128:131], v[32:47]
    ds_read_b128 v[148:151], v249 offset:24576
    ds_read_b64_tr_b16 v[180:181], v252 offset:26624
    ds_read_b64_tr_b16 v[182:183], v252 offset:26880
    s_waitcnt lgkmcnt(12)
    v_mfma_f32_32x32x16_bf16 v[32:47], v[164:167], v[132:135], v[32:47]
    ds_read_b128 v[152:155], v250 offset:24576
    ds_read_b64_tr_b16 v[184:185], v252 offset:28672
    ds_read_b64_tr_b16 v[186:187], v252 offset:28928
    s_waitcnt lgkmcnt(12)
    v_mfma_f32_32x32x16_bf16 v[32:47], v[168:171], v[136:139], v[32:47]
    ds_read_b128 v[156:159], v251 offset:24576
    ds_read_b64_tr_b16 v[188:189], v252 offset:30720
    ds_read_b64_tr_b16 v[190:191], v252 offset:30976
    s_waitcnt lgkmcnt(12)
    v_mfma_f32_32x32x16_bf16 v[32:47], v[172:175], v[140:143], v[32:47]
    ds_read_b32 v20, v53 offset:80
    s_waitcnt lgkmcnt(10)
    v_mfma_f32_32x32x16_bf16 v[32:47], v[176:179], v[144:147], v[32:47]
    s_waitcnt lgkmcnt(7)
    v_mfma_f32_32x32x16_bf16 v[32:47], v[180:183], v[148:151], v[32:47]
    s_waitcnt lgkmcnt(0)
    v_cmp_gt_u32 vcc, 1, v20
    s_cmp_eq_u64 vcc, 0
    s_cbranch_scc1 L_a_14
    v_mfma_f32_32x32x16_bf16 v[32:47], v[184:187], v[152:155], v[32:47]
    v_mfma_f32_32x32x16_bf16 v[32:47], v[188:191], v[156:159], v[32:47]
    s_mov_b32 s46, 0
L_sb_16:
    ds_read_b32 v20, v53 offset:80
    s_waitcnt lgkmcnt(0)
    v_cmp_gt_u32 vcc, 1, v20
    s_add_u32 s46, s46, 1
    s_cmp_eq_u64 vcc, 0
    s_cbranch_scc1 L_sbd_17
    s_cmp_lt_u32 s46, 1600000
    s_cbranch_scc1 L_sb_16
L_sbd_17:
    ds_read_b128 v[128:131], v248 offset:32768
    ds_read_b64_tr_b16 v[160:161], v252 offset:32768
    ds_read_b64_tr_b16 v[162:163], v252 offset:33024
    ds_read_b128 v[132:135], v249 offset:32768
    ds_read_b64_tr_b16 v[164:165], v252 offset:34816
    ds_read_b64_tr_b16 v[166:167], v252 offset:35072
    ds_read_b128 v[136:139], v250 offset:32768
    ds_read_b64_tr_b16 v[168:169], v252 offset:36864
    ds_read_b64_tr_b16 v[170:171], v252 offset:37120
    ds_read_b128 v[140:143], v251 offset:32768
    ds_read_b64_tr_b16 v[172:173], v252 offset:38912
    ds_read_b64_tr_b16 v[174:175], v252 offset:39168
    s_branch L_a_15
L_a_14:
    ds_read_b128 v[128:131], v248 offset:32768
    ds_read_b64_tr_b16 v[160:161], v252 offset:32768
    ds_read_b64_tr_b16 v[162:163], v252 offset:33024
    ds_read_b128 v[132:135], v249 offset:32768
    ds_read_b64_tr_b16 v[164:165], v252 offset:34816
    ds_read_b64_tr_b16 v[166:167], v252 offset:35072
    v_mfma_f32_32x32x16_bf16 v[32:47], v[184:187], v[152:155], v[32:47]
    ds_read_b128 v[136:139], v250 offset:32768
    ds_read_b64_tr_b16 v[168:169], v252 offset:36864
    ds_read_b64_tr_b16 v[170:171], v252 offset:37120
    ds_read_b128 v[140:143], v251 offset:32768
    ds_read_b64_tr_b16 v[172:173], v252 offset:38912
    ds_read_b64_tr_b16 v[174:175], v252 offset:39168
    v_mfma_f32_32x32x16_bf16 v[32:47], v[188:191], v[156:159], v[32:47]
L_a_15:
    ds_read_b128 v[144:147], v248 offset:40960
    ds_read_b64_tr_b16 v[176:177], v252 offset:40960
    ds_read_b64_tr_b16 v[178:179], v252 offset:41216
    s_waitcnt lgkmcnt(12)
    v_mfma_f32_32x32x16_bf16 v[32:47], v[160:163], v[128:131], v[32:47]
    ds_read_b128 v[148:151], v249 offset:40960
    ds_read_b64_tr_b16 v[180:181], v252 offset:43008
    ds_read_b64_tr_b16 v[182:183], v252 offset:43264
    s_waitcnt lgkmcnt(12)
    v_mfma_f32_32x32x16_bf16 v[32:47], v[164:167], v[132:135], v[32:47]
    ds_read_b128 v[152:155], v250 offset:40960
    ds_read_b64_tr_b16 v[184:185], v252 offset:45056
    ds_read_b64_tr_b16 v[186:187], v252 offset:45312
    s_waitcnt lgkmcnt(12)
    v_mfma_f32_32x32x16_bf16 v[32:47], v[168:171], v[136:139], v[32:47]
    ds_read_b128 v[156:159], v251 offset:40960
    ds_read_b64_tr_b16 v[188:189], v252 offset:47104
    ds_read_b64_tr_b16 v[190:191], v252 offset:47360
    s_waitcnt lgkmcnt(12)
    v_mfma_f32_32x32x16_bf16 v[32:47], v[172:175], v[140:143], v[32:47]
    ds_read_b32 v20, v53 offset:96
    s_waitcnt lgkmcnt(10)
    v_mfma_f32_32x32x16_bf16 v[32:47], v[176:179], v[144:147], v[32:47]
    s_waitcnt lgkmcnt(7)
    v_mfma_f32_32x32x16_bf16 v[32:47], v[180:183], v[148:151], v[32:47]
    s_waitcnt lgkmcnt(0)
    v_cmp_gt_u32 vcc, 1, v20
    s_cmp_eq_u64 vcc, 0
    s_cbranch_scc1 L_a_18
    v_mfma_f32_32x32x16_bf16 v[32:47], v[184:187], v[152:155], v[32:47]
    v_mfma_f32_32x32x16_bf16 v[32:47], v[188:191], v[156:159], v[32:47]
    s_mov_b32 s46, 0
L_sb_20:
    ds_read_b32 v20, v53 offset:96
    s_waitcnt lgkmcnt(0)
    v_cmp_gt_u32 vcc, 1, v20
    s_add_u32 s46, s46, 1
    s_cmp_eq_u64 vcc, 0
    s_cbranch_scc1 L_sbd_21
    s_cmp_lt_u32 s46, 1600000
    s_cbranch_scc1 L_sb_20
L_sbd_21:
    ds_read_b128 v[128:131], v248 offset:49152
    ds_read_b64_tr_b16 v[160:161], v252 offset:49152
    ds_read_b64_tr_b16 v[162:163], v252 offset:49408
    ds_read_b128 v[132:135], v249 offset:49152
    ds_read_b64_tr_b16 v[164:165], v252 offset:51200
    ds_read_b64_tr_b16 v[166:167], v252 offset:51456
    ds_read_b128 v[136:139], v250 offset:49152
    ds_read_b64_tr_b16 v[168:169], v252 offset:53248
    ds_read_b64_tr_b16 v[170:171], v252 offset:53504
    ds_read_b128 v[140:143], v251 offset:49152
    ds_read_b64_tr_b16 v[172:173], v252 offset:55296
    ds_read_b64_tr_b16 v[174:175], v252 offset:55552
    s_branch L_a_19
L_a_18:
    ds_read_b128 v[128:131], v248 offset:49152
    ds_read_b64_tr_b16 v[160:161], v252 offset:49152
    ds_read_b64_tr_b16 v[162:163], v252 offset:49408
    ds_read_b128 v[132:135], v249 offset:49152
    ds_read_b64_tr_b16 v[164:165], v252 offset:51200
    ds_read_b64_tr_b16 v[166:167], v252 offset:51456
    v_mfma_f32_32x32x16_bf16 v[32:47], v[184:187], v[152:155], v[32:47]
    ds_read_b128 v[136:139], v250 offset:49152
    ds_read_b64_tr_b16 v[168:169], v252 offset:53248
    ds_read_b64_tr_b16 v[170:171], v252 offset:53504
    ds_read_b128 v[140:143], v251 offset:49152
    ds_read_b64_tr_b16 v[172:173], v252 offset:55296
    ds_read_b64_tr_b16 v[174:175], v252 offset:55552
    v_mfma_f32_32x32x16_bf16 v[32:47], v[188:191], v[156:159], v[32:47]
L_a_19:
    ds_read_b32 v20, v54 offset:112
    s_waitcnt lgkmcnt(10)
    v_mfma_f32_32x32x16_bf16 v[32:47], v[160:163], v[128:131], v[32:47]
    s_waitcnt lgkmcnt(7)
    v_mfma_f32_32x32x16_bf16 v[32:47], v[164:167], v[132:135], v[32:47]
    s_waitcnt lgkmcnt(0)
    v_cmp_gt_u32 vcc, 1, v20
    s_cmp_eq_u64 vcc, 0
    s_cbranch_scc1 L_a_22
    v_mfma_f32_32x32x16_bf16 v[32:47], v[168:171], v[136:139], v[32:47]
    v_mfma_f32_32x32x16_bf16 v[32:47], v[172:175], v[140:143], v[32:47]
    s_mov_b32 s46, 0
L_sb_24:
    ds_read_b32 v20, v54 offset:112
    s_waitcnt lgkmcnt(0)
    v_cmp_gt_u32 vcc, 1, v20
    s_add_u32 s46, s46, 1
    s_cmp_eq_u64 vcc, 0
    s_cbranch_scc1 L_sbd_25
    s_cmp_lt_u32 s46, 1600000
    s_cbranch_scc1 L_sb_24
L_sbd_25:
    ds_read_b128 v[144:147], v248 offset:57344
    ds_read_b64_tr_b16 v[176:177], v252 offset:57344
    ds_read_b64_tr_b16 v[178:179], v252 offset:57600
    ds_read_b128 v[148:151], v249 offset:57344
    ds_read_b64_tr_b16 v[180:181], v252 offset:59392
    ds_read_b64_tr_b16 v[182:183], v252 offset:59648
    ds_read_b128 v[152:155], v250 offset:57344
    ds_read_b64_tr_b16 v[184:185], v252 offset:61440
    ds_read_b64_tr_b16 v[186:187], v252 offset:61696
    ds_read_b128 v[156:159], v251 offset:57344
    ds_read_b64_tr_b16 v[188:189], v252 offset:63488
    ds_read_b64_tr_b16 v[190:191], v252 offset:63744
    s_branch L_a_23
L_a_22:
    ds_read_b128 v[144:147], v248 offset:57344
    ds_read_b64_tr_b16 v[176:177], v252 offset:57344
    ds_read_b64_tr_b16 v[178:179], v252 offset:57600
    ds_read_b128 v[148:151], v249 offset:57344
    ds_read_b64_tr_b16 v[180:181], v252 offset:59392
    ds_read_b64_tr_b16 v[182:183], v252 offset:59648
    v_mfma_f32_32x32x16_bf16 v[32:47], v[168:171], v[136:139], v[32:47]
    ds_read_b128 v[152:155], v250 offset:57344
    ds_read_b64_tr_b16 v[184:185], v252 offset:61440
    ds_read_b64_tr_b16 v[186:187], v252 offset:61696
    ds_read_b128 v[156:159], v251 offset:57344
    ds_read_b64_tr_b16 v[188:189], v252 offset:63488
    ds_read_b64_tr_b16 v[190:191], v252 offset:63744
    v_mfma_f32_32x32x16_bf16 v[32:47], v[172:175], v[140:143], v[32:47]
L_a_23:
    s_barrier
    global_load_dwordx4 v[192:195], v11, s[8:9] sc1
    global_load_dwordx4 v[196:199], v12, s[8:9] offset:640 sc1
    global_load_dwordx4 v[200:203], v12, s[8:9] offset:1920 sc1
    s_waitcnt lgkmcnt(9)
    v_mfma_f32_32x32x16_bf16 v[32:47], v[176:179], v[144:147], v[32:47]
    s_waitcnt lgkmcnt(6)
    v_mfma_f32_32x32x16_bf16 v[32:47], v[180:183], v[148:151], v[32:47]
    s_waitcnt lgkmcnt(3)
    v_mfma_f32_32x32x16_bf16 v[32:47], v[184:187], v[152:155], v[32:47]
    s_waitcnt lgkmcnt(0)
    v_mfma_f32_32x32x16_bf16 v[32:47], v[188:191], v[156:159], v[32:47]
    v_mov_b64 v[184:185], 0
    v_mov_b64 v[186:187], 0
    v_mov_b64 v[188:189], 0
    v_mov_b64 v[190:191], 0
    global_load_dwordx4 v[204:207], v11, s[10:11] sc1
    global_load_dwordx4 v[208:211], v12, s[10:11] offset:640 sc1
    global_load_dwordx4 v[212:215], v12, s[10:11] offset:1920 sc1
    s_nop 4
    v_cvt_pk_bf16_f32 v24, v32, v33
    v_cvt_pk_bf16_f32 v25, v34, v35
    v_cvt_pk_bf16_f32 v26, v36, v37
    v_cvt_pk_bf16_f32 v27, v38, v39
    v_cvt_pk_bf16_f32 v28, v40, v41
    v_cvt_pk_bf16_f32 v29, v42, v43
    v_cvt_pk_bf16_f32 v30, v44, v45
    v_cvt_pk_bf16_f32 v31, v46, v47
    ds_write_b128 v9, v[24:27]
    ds_write_b128 v9, v[28:31] offset:1024
    s_waitcnt lgkmcnt(0)
    s_barrier
    s_setprio 1
    ds_read_b128 v[16:19], v3
    ds_read_b128 v[20:23], v3 offset:1024
    global_load_dwordx4 v[216:219], v11, s[12:13] sc1
    global_load_dwordx4 v[220:223], v12, s[12:13] offset:640 sc1
    global_load_dwordx4 v[224:227], v12, s[12:13] offset:1920 sc1
    s_add_u32 s35, s35, 1
    v_mov_b32 v50, s35
    ds_write_b32 v5, v50
    s_mov_b32 s7, 6
    s_branch L_attn0
.p2align 12
L_attn0_stub:
    s_branch L_opB_stub
    s_nop 0
L_attn0:
    s_waitcnt vmcnt(6) lgkmcnt(0)
    v_mfma_f32_32x32x16_bf16 v[128:143], v[192:195], v[16:19], 0
    s_nop 3
L_attn_26:
    v_exp_f32 v186, v186
    v_exp_f32 v187, v187
    v_exp_f32 v188, v188
    v_exp_f32 v189, v189
    v_exp_f32 v190, v190
    v_exp_f32 v191, v191
    v_mfma_f32_32x32x16_bf16 v[144:159], v[192:195], v[20:23], 0
    s_add_u32 s36, s26, s6
    v_exp_f32 v128, v128
    v_exp_f32 v129, v129
    v_exp_f32 v130, v130
    v_smfmac_f32_32x32x32_bf16 v[112:127], v[236:239], v[184:191], v10
    s_addc_u32 s37, s27, 0
    s_add_u32 s6, s6, 5120
    v_exp_f32 v131, v131
    v_exp_f32 v132, v132
    v_exp_f32 v133, v133
    v_exp_f32 v134, v134
    v_exp_f32 v135, v135
    v_exp_f32 v136, v136
    v_exp_f32 v137, v137
    v_smfmac_f32_32x32x32_bf16 v[64:79], v[196:199], v[128:135], v10
    s_cmp_ge_u32 s6, 294912
    s_cselect_b32 s38, 163840, 0
    v_exp_f32 v138, v138
    v_exp_f32 v139, v139
    v_exp_f32 v140, v140
    v_exp_f32 v141, v141
    v_exp_f32 v142, v142
    v_exp_f32 v143, v143
    v_mfma_f32_32x32x16_bf16 v[160:175], v[192:195], v[24:27], 0
    s_sub_u32 s6, s6, s38
    v_exp_f32 v144, v144
    v_exp_f32 v145, v145
    v_exp_f32 v146, v146
    v_smfmac_f32_32x32x32_bf16 v[64:79], v[200:203], v[136:143], v10
    global_load_dwordx4 v[228:231], v11, s[36:37] sc1
    v_exp_f32 v147, v147
    v_exp_f32 v148, v148
    v_exp_f32 v149, v149
    v_exp_f32 v150, v150
    v_exp_f32 v151, v151
    v_exp_f32 v152, v152
    v_exp_f32 v153, v153
    v_smfmac_f32_32x32x32_bf16 v[80:95], v[196:199], v[144:151], v10
    global_load_dwordx4 v[232:235], v12, s[36:37] offset:640 sc1
    v_exp_f32 v154, v154
    v_exp_f32 v155, v155
    v_exp_f32 v156, v156
    v_exp_f32 v157, v157
    v_exp_f32 v158, v158
    v_exp_f32 v159, v159
    v_mfma_f32_32x32x16_bf16 v[176:191], v[192:195], v[28:31], 0
    v_exp_f32 v160, v160
    v_exp_f32 v161, v161
    v_exp_f32 v162, v162
    v_smfmac_f32_32x32x32_bf16 v[80:95], v[200:203], v[152:159], v10
    global_load_dwordx4 v[236:239], v12, s[36:37] offset:1920 sc1
    v_exp_f32 v163, v163
    v_exp_f32 v164, v164
    v_exp_f32 v165, v165
    v_exp_f32 v166, v166
    v_exp_f32 v167, v167
    v_exp_f32 v168, v168
    v_exp_f32 v169, v169
    v_smfmac_f32_32x32x32_bf16 v[96:111], v[196:199], v[160:167], v10
    s_waitcnt vmcnt(6)
    v_exp_f32 v170, v170
    v_exp_f32 v171, v171
    v_exp_f32 v172, v172
    v_exp_f32 v173, v173
    v_exp_f32 v174, v174
    v_exp_f32 v175, v175
    v_mfma_f32_32x32x16_bf16 v[128:143], v[204:207], v[16:19], 0
    v_exp_f32 v176, v176
    v_exp_f32 v177, v177
    v_exp_f32 v178, v178
    v_smfmac_f32_32x32x32_bf16 v[96:111], v[200:203], v[168:175], v10
    v_exp_f32 v179, v179
    v_exp_f32 v180, v180
    v_exp_f32 v181, v181
    v_exp_f32 v182, v182
    v_exp_f32 v183, v183
    v_exp_f32 v184, v184
    v_exp_f32 v185, v185
    v_smfmac_f32_32x32x32_bf16 v[112:127], v[196:199], v[176:183], v10
    v_exp_f32 v186, v186
    v_exp_f32 v187, v187
    v_exp_f32 v188, v188
    v_exp_f32 v189, v189
    v_exp_f32 v190, v190
    v_exp_f32 v191, v191
    v_mfma_f32_32x32x16_bf16 v[144:159], v[204:207], v[20:23], 0
    s_add_u32 s36, s26, s6
    v_exp_f32 v128, v128
    v_exp_f32 v129, v129
    v_exp_f32 v130, v130
    v_smfmac_f32_32x32x32_bf16 v[112:127], v[200:203], v[184:191], v10
    s_addc_u32 s37, s27, 0
    s_add_u32 s6, s6, 5120
    v_exp_f32 v131, v131
    v_exp_f32 v132, v132
    v_exp_f32 v133, v133
    v_exp_f32 v134, v134
    v_exp_f32 v135, v135
    v_exp_f32 v136, v136
    v_exp_f32 v137, v137
    v_smfmac_f32_32x32x32_bf16 v[64:79], v[208:211], v[128:135], v10
    s_cmp_ge_u32 s6, 294912
    s_cselect_b32 s38, 163840, 0
    v_exp_f32 v138, v138
    v_exp_f32 v139, v139
    v_exp_f32 v140, v140
    v_exp_f32 v141, v141
    v_exp_f32 v142, v142
    v_exp_f32 v143, v143
    v_mfma_f32_32x32x16_bf16 v[160:175], v[204:207], v[24:27], 0
    s_sub_u32 s6, s6, s38
    v_exp_f32 v144, v144
    v_exp_f32 v145, v145
    v_exp_f32 v146, v146
    v_smfmac_f32_32x32x32_bf16 v[64:79], v[212:215], v[136:143], v10
    global_load_dwordx4 v[192:195], v11, s[36:37] sc1
    v_exp_f32 v147, v147
    v_exp_f32 v148, v148
    v_exp_f32 v149, v149
    v_exp_f32 v150, v150
    v_exp_f32 v151, v151
    v_exp_f32 v152, v152
    v_exp_f32 v153, v153
    v_smfmac_f32_32x32x32_bf16 v[80:95], v[208:211], v[144:151], v10
    global_load_dwordx4 v[196:199], v12, s[36:37] offset:640 sc1
    v_exp_f32 v154, v154
    v_exp_f32 v155, v155
    v_exp_f32 v156, v156
    v_exp_f32 v157, v157
    v_exp_f32 v158, v158
    v_exp_f32 v159, v159
    v_mfma_f32_32x32x16_bf16 v[176:191], v[204:207], v[28:31], 0
    v_exp_f32 v160, v160
    v_exp_f32 v161, v161
    v_exp_f32 v162, v162
    v_smfmac_f32_32x32x32_bf16 v[80:95], v[212:215], v[152:159], v10
    global_load_dwordx4 v[200:203], v12, s[36:37] offset:1920 sc1
    v_exp_f32 v163, v163
    v_exp_f32 v164, v164
    v_exp_f32 v165, v165
    v_exp_f32 v166, v166
    v_exp_f32 v167, v167
    v_exp_f32 v168, v168
    v_exp_f32 v169, v169
    v_smfmac_f32_32x32x32_bf16 v[96:111], v[208:211], v[160:167], v10
    s_waitcnt vmcnt(6)
    v_exp_f32 v170, v170
    v_exp_f32 v171, v171
    v_exp_f32 v172, v172
    v_exp_f32 v173, v173
    v_exp_f32 v174, v174
    v_exp_f32 v175, v175
    v_mfma_f32_32x32x16_bf16 v[128:143], v[216:219], v[16:19], 0
    v_exp_f32 v176, v176
    v_exp_f32 v177, v177
    v_exp_f32 v178, v178
    v_smfmac_f32_32x32x32_bf16 v[96:111], v[212:215], v[168:175], v10
    v_exp_f32 v179, v179
    v_exp_f32 v180, v180
    v_exp_f32 v181, v181
    v_exp_f32 v182, v182
    v_exp_f32 v183, v183
    v_exp_f32 v184, v184
    v_exp_f32 v185, v185
    v_smfmac_f32_32x32x32_bf16 v[112:127], v[208:211], v[176:183], v10
    v_exp_f32 v186, v186
    v_exp_f32 v187, v187
    v_exp_f32 v188, v188
    v_exp_f32 v189, v189
    v_exp_f32 v190, v190
    v_exp_f32 v191, v191
    v_mfma_f32_32x32x16_bf16 v[144:159], v[216:219], v[20:23], 0
    s_add_u32 s36, s26, s6
    v_exp_f32 v128, v128
    v_exp_f32 v129, v129
    v_exp_f32 v130, v130
    v_smfmac_f32_32x32x32_bf16 v[112:127], v[212:215], v[184:191], v10
    s_addc_u32 s37, s27, 0
    s_add_u32 s6, s6, 5120
    v_exp_f32 v131, v131
    v_exp_f32 v132, v132
    v_exp_f32 v133, v133
    v_exp_f32 v134, v134
    v_exp_f32 v135, v135
    v_exp_f32 v136, v136
    v_exp_f32 v137, v137
    v_smfmac_f32_32x32x32_bf16 v[64:79], v[220:223], v[128:135], v10
    s_cmp_ge_u32 s6, 294912
    s_cselect_b32 s38, 163840, 0
    v_exp_f32 v138, v138
    v_exp_f32 v139, v139
    v_exp_f32 v140, v140
    v_exp_f32 v141, v141
    v_exp_f32 v142, v142
    v_exp_f32 v143, v143
    v_mfma_f32_32x32x16_bf16 v[160:175], v[216:219], v[24:27], 0
    s_sub_u32 s6, s6, s38
    v_exp_f32 v144, v144
    v_exp_f32 v145, v145
    v_exp_f32 v146, v146
    v_smfmac_f32_32x32x32_bf16 v[64:79], v[224:227], v[136:143], v10
    global_load_dwordx4 v[204:207], v11, s[36:37] sc1
    v_exp_f32 v147, v147
    v_exp_f32 v148, v148
    v_exp_f32 v149, v149
    v_exp_f32 v150, v150
    v_exp_f32 v151, v151
    v_exp_f32 v152, v152
    v_exp_f32 v153, v153
    v_smfmac_f32_32x32x32_bf16 v[80:95], v[220:223], v[144:151], v10
    global_load_dwordx4 v[208:211], v12, s[36:37] offset:640 sc1
    v_exp_f32 v154, v154
    v_exp_f32 v155, v155
    v_exp_f32 v156, v156
    v_exp_f32 v157, v157
    v_exp_f32 v158, v158
    v_exp_f32 v159, v159
    v_mfma_f32_32x32x16_bf16 v[176:191], v[216:219], v[28:31], 0
    v_exp_f32 v160, v160
    v_exp_f32 v161, v161
    v_exp_f32 v162, v162
    v_smfmac_f32_32x32x32_bf16 v[80:95], v[224:227], v[152:159], v10
    global_load_dwordx4 v[212:215], v12, s[36:37] offset:1920 sc1
    v_exp_f32 v163, v163
    v_exp_f32 v164, v164
    v_exp_f32 v165, v165
    v_exp_f32 v166, v166
    v_exp_f32 v167, v167
    v_exp_f32 v168, v168
    v_exp_f32 v169, v169
    v_smfmac_f32_32x32x32_bf16 v[96:111], v[220:223], v[160:167], v10
    s_waitcnt vmcnt(6)
    v_exp_f32 v170, v170
    v_exp_f32 v171, v171
    v_exp_f32 v172, v172
    v_exp_f32 v173, v173
    v_exp_f32 v174, v174
    v_exp_f32 v175, v175
    v_mfma_f32_32x32x16_bf16 v[128:143], v[228:231], v[16:19], 0
    v_exp_f32 v176, v176
    v_exp_f32 v177, v177
    v_exp_f32 v178, v178
    v_smfmac_f32_32x32x32_bf16 v[96:111], v[224:227], v[168:175], v10
    ds_read_b32 v50, v51
    v_exp_f32 v179, v179
    v_exp_f32 v180, v180
    v_exp_f32 v181, v181
    v_exp_f32 v182, v182
    v_exp_f32 v183, v183
    v_exp_f32 v184, v184
    v_exp_f32 v185, v185
    v_smfmac_f32_32x32x32_bf16 v[112:127], v[220:223], v[176:183], v10
    v_exp_f32 v186, v186
    v_exp_f32 v187, v187
    v_exp_f32 v188, v188
    v_exp_f32 v189, v189
    v_exp_f32 v190, v190
    v_exp_f32 v191, v191
    v_mfma_f32_32x32x16_bf16 v[144:159], v[228:231], v[20:23], 0
    s_add_u32 s36, s26, s6
    v_exp_f32 v128, v128
    v_exp_f32 v129, v129
    v_exp_f32 v130, v130
    v_smfmac_f32_32x32x32_bf16 v[112:127], v[224:227], v[184:191], v10
    s_addc_u32 s37, s27, 0
    s_add_u32 s6, s6, 5120
    v_exp_f32 v131, v131
    v_exp_f32 v132, v132
    v_exp_f32 v133, v133
    v_exp_f32 v134, v134
    v_exp_f32 v135, v135
    v_exp_f32 v136, v136
    v_exp_f32 v137, v137
    v_smfmac_f32_32x32x32_bf16 v[64:79], v[232:235], v[128:135], v10
    s_cmp_ge_u32 s6, 294912
    s_cselect_b32 s38, 163840, 0
    v_exp_f32 v138, v138
    v_exp_f32 v139, v139
    v_exp_f32 v140, v140
    v_exp_f32 v141, v141
    v_exp_f32 v142, v142
    v_exp_f32 v143, v143
    v_mfma_f32_32x32x16_bf16 v[160:175], v[228:231], v[24:27], 0
    s_sub_u32 s6, s6, s38
    v_exp_f32 v144, v144
    v_exp_f32 v145, v145
    v_exp_f32 v146, v146
    v_smfmac_f32_32x32x32_bf16 v[64:79], v[236:239], v[136:143], v10
    global_load_dwordx4 v[216:219], v11, s[36:37] sc1
    v_exp_f32 v147, v147
    v_exp_f32 v148, v148
    v_exp_f32 v149, v149
    v_exp_f32 v150, v150
    v_exp_f32 v151, v151
    v_exp_f32 v152, v152
    v_exp_f32 v153, v153
    v_smfmac_f32_32x32x32_bf16 v[80:95], v[232:235], v[144:151], v10
    global_load_dwordx4 v[220:223], v12, s[36:37] offset:640 sc1
    v_exp_f32 v154, v154
    v_exp_f32 v155, v155
    v_exp_f32 v156, v156
    v_exp_f32 v157, v157
    v_exp_f32 v158, v158
    v_exp_f32 v159, v159
    v_mfma_f32_32x32x16_bf16 v[176:191], v[228:231], v[28:31], 0
    v_exp_f32 v160, v160
    v_exp_f32 v161, v161
    v_exp_f32 v162, v162
    v_smfmac_f32_32x32x32_bf16 v[80:95], v[236:239], v[152:159], v10
    global_load_dwordx4 v[224:227], v12, s[36:37] offset:1920 sc1
    v_exp_f32 v163, v163
    v_exp_f32 v164, v164
    v_exp_f32 v165, v165
    v_exp_f32 v166, v166
    v_exp_f32 v167, v167
    v_exp_f32 v168, v168
    v_exp_f32 v169, v169
    v_smfmac_f32_32x32x32_bf16 v[96:111], v[232:235], v[160:167], v10
    s_waitcnt vmcnt(6)
    v_exp_f32 v170, v170
    v_exp_f32 v171, v171
    v_exp_f32 v172, v172
    v_exp_f32 v173, v173
    v_exp_f32 v174, v174
    v_exp_f32 v175, v175
    v_mfma_f32_32x32x16_bf16 v[128:143], v[192:195], v[16:19], 0
    s_waitcnt lgkmcnt(0)
    v_cmp_gt_u32 vcc, s35, v50
    v_exp_f32 v176, v176
    v_exp_f32 v177, v177
    v_exp_f32 v178, v178
    v_smfmac_f32_32x32x32_bf16 v[96:111], v[236:239], v[168:175], v10
    s_cbranch_vccnz L_check
L_checked:
    s_sub_u32 s7, s7, 1
    v_exp_f32 v179, v179
    v_exp_f32 v180, v180
    v_exp_f32 v181, v181
    v_exp_f32 v182, v182
    v_exp_f32 v183, v183
    v_exp_f32 v184, v184
    v_exp_f32 v185, v185
    v_smfmac_f32_32x32x32_bf16 v[112:127], v[232:235], v[176:183], v10
    s_cbranch_scc0 L_attn_26
    v_exp_f32 v186, v186
    v_exp_f32 v187, v187
    v_exp_f32 v188, v188
    v_exp_f32 v189, v189
    v_exp_f32 v190, v190
    v_exp_f32 v191, v191
    v_mfma_f32_32x32x16_bf16 v[144:159], v[192:195], v[20:23], 0
    s_add_u32 s36, s26, s6
    v_exp_f32 v128, v128
    v_exp_f32 v129, v129
    v_exp_f32 v130, v130
    v_smfmac_f32_32x32x32_bf16 v[112:127], v[236:239], v[184:191], v10
    s_addc_u32 s37, s27, 0
    s_add_u32 s6, s6, 5120
    v_exp_f32 v131, v131
    v_exp_f32 v132, v132
    v_exp_f32 v133, v133
    v_exp_f32 v134, v134
    v_exp_f32 v135, v135
    v_exp_f32 v136, v136
    v_exp_f32 v137, v137
    v_smfmac_f32_32x32x32_bf16 v[64:79], v[196:199], v[128:135], v10
    s_cmp_ge_u32 s6, 294912
    s_cselect_b32 s38, 163840, 0
    v_exp_f32 v138, v138
    v_exp_f32 v139, v139
    v_exp_f32 v140, v140
    v_exp_f32 v141, v141
    v_exp_f32 v142, v142
    v_exp_f32 v143, v143
    v_mfma_f32_32x32x16_bf16 v[160:175], v[192:195], v[24:27], 0
    s_sub_u32 s6, s6, s38
    v_exp_f32 v144, v144
    v_exp_f32 v145, v145
    v_exp_f32 v146, v146
    v_smfmac_f32_32x32x32_bf16 v[64:79], v[200:203], v[136:143], v10
    global_load_dwordx4 v[228:231], v11, s[36:37] sc1
    v_exp_f32 v147, v147
    v_exp_f32 v148, v148
    v_exp_f32 v149, v149
    v_exp_f32 v150, v150
    v_exp_f32 v151, v151
    v_exp_f32 v152, v152
    v_exp_f32 v153, v153
    v_smfmac_f32_32x32x32_bf16 v[80:95], v[196:199], v[144:151], v10
    global_load_dwordx4 v[232:235], v12, s[36:37] offset:640 sc1
    v_exp_f32 v154, v154
    v_exp_f32 v155, v155
    v_exp_f32 v156, v156
    v_exp_f32 v157, v157
    v_exp_f32 v158, v158
    v_exp_f32 v159, v159
    v_mfma_f32_32x32x16_bf16 v[176:191], v[192:195], v[28:31], 0
    v_exp_f32 v160, v160
    v_exp_f32 v161, v161
    v_exp_f32 v162, v162
    v_smfmac_f32_32x32x32_bf16 v[80:95], v[200:203], v[152:159], v10
    global_load_dwordx4 v[236:239], v12, s[36:37] offset:1920 sc1
    v_exp_f32 v163, v163
    v_exp_f32 v164, v164
    v_exp_f32 v165, v165
    v_exp_f32 v166, v166
    v_exp_f32 v167, v167
    v_exp_f32 v168, v168
    v_exp_f32 v169, v169
    v_smfmac_f32_32x32x32_bf16 v[96:111], v[196:199], v[160:167], v10
    s_waitcnt vmcnt(6)
    v_exp_f32 v170, v170
    v_exp_f32 v171, v171
    v_exp_f32 v172, v172
    v_exp_f32 v173, v173
    v_exp_f32 v174, v174
    v_exp_f32 v175, v175
    v_mfma_f32_32x32x16_bf16 v[128:143], v[204:207], v[16:19], 0
    v_exp_f32 v176, v176
    v_exp_f32 v177, v177
    v_exp_f32 v178, v178
    v_smfmac_f32_32x32x32_bf16 v[96:111], v[200:203], v[168:175], v10
    v_exp_f32 v179, v179
    v_exp_f32 v180, v180
    v_exp_f32 v181, v181
    v_exp_f32 v182, v182
    v_exp_f32 v183, v183
    v_exp_f32 v184, v184
    v_exp_f32 v185, v185
    v_smfmac_f32_32x32x32_bf16 v[112:127], v[196:199], v[176:183], v10
    v_exp_f32 v186, v186
    v_exp_f32 v187, v187
    v_exp_f32 v188, v188
    v_exp_f32 v189, v189
    v_exp_f32 v190, v190
    v_exp_f32 v191, v191
    v_mfma_f32_32x32x16_bf16 v[144:159], v[204:207], v[20:23], 0
    v_exp_f32 v128, v128
    v_exp_f32 v129, v129
    v_exp_f32 v130, v130
    v_smfmac_f32_32x32x32_bf16 v[112:127], v[200:203], v[184:191], v10
    v_exp_f32 v131, v131
    v_exp_f32 v132, v132
    v_exp_f32 v133, v133
    v_exp_f32 v134, v134
    v_exp_f32 v135, v135
    v_exp_f32 v136, v136
    v_exp_f32 v137, v137
    v_smfmac_f32_32x32x32_bf16 v[64:79], v[208:211], v[128:135], v10
    v_exp_f32 v138, v138
    v_exp_f32 v139, v139
    v_exp_f32 v140, v140
    v_exp_f32 v141, v141
    v_exp_f32 v142, v142
    v_exp_f32 v143, v143
    v_mfma_f32_32x32x16_bf16 v[160:175], v[204:207], v[24:27], 0
    v_exp_f32 v144, v144
    v_exp_f32 v145, v145
    v_exp_f32 v146, v146
    v_smfmac_f32_32x32x32_bf16 v[64:79], v[212:215], v[136:143], v10
    v_exp_f32 v147, v147
    v_exp_f32 v148, v148
    v_exp_f32 v149, v149
    v_exp_f32 v150, v150
    v_exp_f32 v151, v151
    v_exp_f32 v152, v152
    v_exp_f32 v153, v153
    v_smfmac_f32_32x32x32_bf16 v[80:95], v[208:211], v[144:151], v10
    v_exp_f32 v154, v154
    v_exp_f32 v155, v155
    v_exp_f32 v156, v156
    v_exp_f32 v157, v157
    v_exp_f32 v158, v158
    v_exp_f32 v159, v159
    v_mfma_f32_32x32x16_bf16 v[176:191], v[204:207], v[28:31], 0
    v_exp_f32 v160, v160
    v_exp_f32 v161, v161
    v_exp_f32 v162, v162
    v_smfmac_f32_32x32x32_bf16 v[80:95], v[212:215], v[152:159], v10
    v_exp_f32 v163, v163
    v_exp_f32 v164, v164
    v_exp_f32 v165, v165
    v_exp_f32 v166, v166
    v_exp_f32 v167, v167
    v_exp_f32 v168, v168
    v_exp_f32 v169, v169
    v_smfmac_f32_32x32x32_bf16 v[96:111], v[208:211], v[160:167], v10
    s_waitcnt vmcnt(3)
    v_exp_f32 v170, v170
    v_exp_f32 v171, v171
    v_exp_f32 v172, v172
    v_exp_f32 v173, v173
    v_exp_f32 v174, v174
    v_exp_f32 v175, v175
    v_mfma_f32_32x32x16_bf16 v[128:143], v[216:219], v[16:19], 0
    v_exp_f32 v176, v176
    v_exp_f32 v177, v177
    v_exp_f32 v178, v178
    v_smfmac_f32_32x32x32_bf16 v[96:111], v[212:215], v[168:175], v10
    v_exp_f32 v179, v179
    v_exp_f32 v180, v180
    v_exp_f32 v181, v181
    v_exp_f32 v182, v182
    v_exp_f32 v183, v183
    v_exp_f32 v184, v184
    v_exp_f32 v185, v185
    v_smfmac_f32_32x32x32_bf16 v[112:127], v[208:211], v[176:183], v10
    v_exp_f32 v186, v186
    v_exp_f32 v187, v187
    v_exp_f32 v188, v188
    v_exp_f32 v189, v189
    v_exp_f32 v190, v190
    v_exp_f32 v191, v191
    v_mfma_f32_32x32x16_bf16 v[144:159], v[216:219], v[20:23], 0
    v_exp_f32 v128, v128
    v_exp_f32 v129, v129
    v_exp_f32 v130, v130
    v_smfmac_f32_32x32x32_bf16 v[112:127], v[212:215], v[184:191], v10
    v_exp_f32 v131, v131
    v_exp_f32 v132, v132
    v_exp_f32 v133, v133
    v_exp_f32 v134, v134
    v_exp_f32 v135, v135
    v_exp_f32 v136, v136
    v_exp_f32 v137, v137
    v_smfmac_f32_32x32x32_bf16 v[64:79], v[220:223], v[128:135], v10
    v_exp_f32 v138, v138
    v_exp_f32 v139, v139
    v_exp_f32 v140, v140
    v_exp_f32 v141, v141
    v_exp_f32 v142, v142
    v_exp_f32 v143, v143
    v_mfma_f32_32x32x16_bf16 v[160:175], v[216:219], v[24:27], 0
    v_exp_f32 v144, v144
    v_exp_f32 v145, v145
    v_exp_f32 v146, v146
    v_smfmac_f32_32x32x32_bf16 v[64:79], v[224:227], v[136:143], v10
    v_exp_f32 v147, v147
    v_exp_f32 v148, v148
    v_exp_f32 v149, v149
    v_exp_f32 v150, v150
    v_exp_f32 v151, v151
    v_exp_f32 v152, v152
    v_exp_f32 v153, v153
    v_smfmac_f32_32x32x32_bf16 v[80:95], v[220:223], v[144:151], v10
    v_exp_f32 v154, v154
    v_exp_f32 v155, v155
    v_exp_f32 v156, v156
    v_exp_f32 v157, v157
    v_exp_f32 v158, v158
    v_exp_f32 v159, v159
    v_mfma_f32_32x32x16_bf16 v[176:191], v[216:219], v[28:31], 0
    v_exp_f32 v160, v160
    v_exp_f32 v161, v161
    v_exp_f32 v162, v162
    v_smfmac_f32_32x32x32_bf16 v[80:95], v[224:227], v[152:159], v10
    v_exp_f32 v163, v163
    v_exp_f32 v164, v164
    v_exp_f32 v165, v165
    v_exp_f32 v166, v166
    v_exp_f32 v167, v167
    v_exp_f32 v168, v168
    v_exp_f32 v169, v169
    v_smfmac_f32_32x32x32_bf16 v[96:111], v[220:223], v[160:167], v10
    s_waitcnt vmcnt(0)
    v_exp_f32 v170, v170
    v_exp_f32 v171, v171
    v_exp_f32 v172, v172
    v_exp_f32 v173, v173
    v_exp_f32 v174, v174
    v_exp_f32 v175, v175
    v_mfma_f32_32x32x16_bf16 v[128:143], v[228:231], v[16:19], 0
    v_exp_f32 v176, v176
    v_exp_f32 v177, v177
    v_exp_f32 v178, v178
    v_smfmac_f32_32x32x32_bf16 v[96:111], v[224:227], v[168:175], v10
    v_exp_f32 v179, v179
    v_exp_f32 v180, v180
    v_exp_f32 v181, v181
    v_exp_f32 v182, v182
    v_exp_f32 v183, v183
    v_exp_f32 v184, v184
    v_exp_f32 v185, v185
    v_smfmac_f32_32x32x32_bf16 v[112:127], v[220:223], v[176:183], v10
    v_exp_f32 v186, v186
    v_exp_f32 v187, v187
    v_exp_f32 v188, v188
    v_exp_f32 v189, v189
    v_exp_f32 v190, v190
    v_exp_f32 v191, v191
    v_mfma_f32_32x32x16_bf16 v[144:159], v[228:231], v[20:23], 0
    v_exp_f32 v128, v128
    v_exp_f32 v129, v129
    v_exp_f32 v130, v130
    v_smfmac_f32_32x32x32_bf16 v[112:127], v[224:227], v[184:191], v10
    v_exp_f32 v131, v131
    v_exp_f32 v132, v132
    v_exp_f32 v133, v133
    v_exp_f32 v134, v134
    v_exp_f32 v135, v135
    v_exp_f32 v136, v136
    v_exp_f32 v137, v137
    v_smfmac_f32_32x32x32_bf16 v[64:79], v[232:235], v[128:135], v10
    v_exp_f32 v138, v138
    v_exp_f32 v139, v139
    v_exp_f32 v140, v140
    v_exp_f32 v141, v141
    v_exp_f32 v142, v142
    v_exp_f32 v143, v143
    v_mfma_f32_32x32x16_bf16 v[160:175], v[228:231], v[24:27], 0
    v_exp_f32 v144, v144
    v_exp_f32 v145, v145
    v_exp_f32 v146, v146
    v_smfmac_f32_32x32x32_bf16 v[64:79], v[236:239], v[136:143], v10
    v_exp_f32 v147, v147
    v_exp_f32 v148, v148
    v_exp_f32 v149, v149
    v_exp_f32 v150, v150
    v_exp_f32 v151, v151
    v_exp_f32 v152, v152
    v_exp_f32 v153, v153
    v_smfmac_f32_32x32x32_bf16 v[80:95], v[232:235], v[144:151], v10
    v_exp_f32 v154, v154
    v_exp_f32 v155, v155
    v_exp_f32 v156, v156
    v_exp_f32 v157, v157
    v_exp_f32 v158, v158
    v_exp_f32 v159, v159
    v_mfma_f32_32x32x16_bf16 v[176:191], v[228:231], v[28:31], 0
    ds_write_b128 v9, v[64:67] offset:0
    v_exp_f32 v160, v160
    v_exp_f32 v161, v161
    v_exp_f32 v162, v162
    v_smfmac_f32_32x32x32_bf16 v[80:95], v[236:239], v[152:159], v10
    ds_write_b128 v9, v[68:71] offset:1024
    ds_write_b32 v48, v72 offset:0
    v_exp_f32 v163, v163
    v_exp_f32 v164, v164
    v_exp_f32 v165, v165
    v_exp_f32 v166, v166
    v_exp_f32 v167, v167
    v_exp_f32 v168, v168
    v_exp_f32 v169, v169
    v_smfmac_f32_32x32x32_bf16 v[96:111], v[232:235], v[160:167], v10
    v_exp_f32 v170, v170
    v_exp_f32 v171, v171
    v_exp_f32 v172, v172
    v_exp_f32 v173, v173
    v_exp_f32 v174, v174
    v_exp_f32 v175, v175
    ds_write_b128 v9, v[80:83] offset:2048
    v_exp_f32 v176, v176
    v_exp_f32 v177, v177
    v_exp_f32 v178, v178
    v_smfmac_f32_32x32x32_bf16 v[96:111], v[236:239], v[168:175], v10
    ds_write_b128 v9, v[84:87] offset:3072
    ds_write_b32 v48, v88 offset:256
    ds_write_b32 v5, v61
    v_exp_f32 v179, v179
    v_exp_f32 v180, v180
    v_exp_f32 v181, v181
    v_exp_f32 v182, v182
    v_exp_f32 v183, v183
    v_exp_f32 v184, v184
    v_exp_f32 v185, v185
    v_smfmac_f32_32x32x32_bf16 v[112:127], v[232:235], v[176:183], v10
    v_exp_f32 v186, v186
    v_exp_f32 v187, v187
    v_exp_f32 v188, v188
    v_exp_f32 v189, v189
    v_exp_f32 v190, v190
    v_exp_f32 v191, v191
    ds_read_b32 v50, v60
    ds_read_b32 v72, v49
    v_smfmac_f32_32x32x32_bf16 v[112:127], v[236:239], v[184:191], v10
    ds_read_b32 v88, v49 offset:256
    ds_read_b128 v[64:67], v3
    ds_read_b128 v[68:71], v3 offset:1024
    ds_read_b128 v[80:83], v3 offset:2048
    ds_read_b128 v[84:87], v3 offset:3072
    s_mov_b32 s38, 0x35800000
    s_mov_b32 s39, 0x71800000
    s_waitcnt lgkmcnt(6)
    v_cmp_gt_u32 vcc, 30, v50
    s_cmp_eq_u64 vcc, 0
    s_cbranch_scc1 L_x_27
    s_mov_b32 s46, 0
L_sb_29:
    ds_read_b32 v50, v60 offset:0
    s_waitcnt lgkmcnt(0)
    v_cmp_gt_u32 vcc, 30, v50
    s_add_u32 s46, s46, 1
    s_cmp_eq_u64 vcc, 0
    s_cbranch_scc1 L_sbd_30
    s_cmp_lt_u32 s46, 1600000
    s_cbranch_scc1 L_sb_29
L_sbd_30:
    ds_read_b32 v72, v49
    ds_read_b32 v88, v49 offset:256
    ds_read_b128 v[64:67], v3
    ds_read_b128 v[68:71], v3 offset:1024
    ds_read_b128 v[80:83], v3 offset:2048
    ds_read_b128 v[84:87], v3 offset:3072
L_x_27:
    s_waitcnt lgkmcnt(2)
    v_add_f32 v104, v104, v72
    v_add_f32 v120, v120, v88
    v_cmp_le_f32 s[40:41], s38, v104
    v_cmp_le_f32 s[42:43], s38, v120
    v_add_f32 v73, v104, v120
    v_pk_add_f32 v[96:97], v[96:97], v[64:65]
    v_pk_add_f32 v[98:99], v[98:99], v[66:67]
    v_pk_add_f32 v[100:101], v[100:101], v[68:69]
    v_pk_add_f32 v[102:103], v[102:103], v[70:71]
    s_waitcnt lgkmcnt(0)
    v_pk_add_f32 v[112:113], v[112:113], v[80:81]
    v_pk_add_f32 v[114:115], v[114:115], v[82:83]
    v_pk_add_f32 v[116:117], v[116:117], v[84:85]
    v_pk_add_f32 v[118:119], v[118:119], v[86:87]
    v_pk_add_f32 v[64:65], v[96:97], v[98:99]
    v_pk_add_f32 v[66:67], v[100:101], v[102:103]
    v_pk_add_f32 v[68:69], v[112:113], v[114:115]
    v_pk_add_f32 v[70:71], v[116:117], v[118:119]
    v_pk_add_f32 v[64:65], v[64:65], v[66:67]
    v_pk_add_f32 v[68:69], v[68:69], v[70:71]
    s_and_b64 s[40:41], s[40:41], s[42:43]
    v_pk_add_f32 v[64:65], v[64:65], v[68:69]
    v_fma_f32 v73, v64, 0, v73
    v_fma_f32 v73, v65, 0, v73
    v_cmp_ge_f32 vcc, s39, v73
    s_and_b64 vcc, vcc, s[40:41]
    s_cmp_eq_u64 vcc, -1
    s_cbranch_scc0 L_fallback
L_norm:
    v_rcp_f32 v104, v104
    v_rcp_f32 v120, v120
    v_pk_mul_f32 v[96:97], v[96:97], v[104:105] op_sel_hi:[1,0]
    v_pk_mul_f32 v[98:99], v[98:99], v[104:105] op_sel_hi:[1,0]
    v_pk_mul_f32 v[100:101], v[100:101], v[104:105] op_sel_hi:[1,0]
    v_pk_mul_f32 v[102:103], v[102:103], v[104:105] op_sel_hi:[1,0]
    v_cvt_pk_bf16_f32 v16, v96, v97
    v_cvt_pk_bf16_f32 v17, v98, v99
    v_cvt_pk_bf16_f32 v18, v100, v101
    v_cvt_pk_bf16_f32 v19, v102, v103
    v_min_u32 v16, -2, v16
    global_store_dwordx4 v13, v[16:19], s[26:27] offset:0 sc1
    v_pk_mul_f32 v[112:113], v[112:113], v[120:121] op_sel_hi:[1,0]
    v_pk_mul_f32 v[114:115], v[114:115], v[120:121] op_sel_hi:[1,0]
    v_pk_mul_f32 v[116:117], v[116:117], v[120:121] op_sel_hi:[1,0]
    v_pk_mul_f32 v[118:119], v[118:119], v[120:121] op_sel_hi:[1,0]
    v_cvt_pk_bf16_f32 v20, v112, v113
    v_cvt_pk_bf16_f32 v21, v114, v115
    v_cvt_pk_bf16_f32 v22, v116, v117
    v_cvt_pk_bf16_f32 v23, v118, v119
    v_min_u32 v20, -2, v20
    global_store_dwordx4 v13, v[20:23], s[26:27] offset:1024 sc1
    s_setprio 0
    s_branch L_opB
.p2align 12
L_opB_stub:
    s_branch L_warmed
    s_nop 0
L_opB:
    s_barrier
    ds_read_b128 v[128:131], v14 offset:0
    ds_read_b64_tr_b16 v[160:161], v8 offset:0
    ds_read_b64_tr_b16 v[162:163], v8 offset:1024
    ds_read_b128 v[132:135], v14 offset:1024
    ds_read_b64_tr_b16 v[164:165], v8 offset:2048
    ds_read_b64_tr_b16 v[166:167], v8 offset:3072
    ds_read_b128 v[136:139], v14 offset:2048
    ds_read_b64_tr_b16 v[168:169], v8 offset:4096
    ds_read_b64_tr_b16 v[170:171], v8 offset:5120
    ds_read_b128 v[140:143], v14 offset:3072
    ds_read_b64_tr_b16 v[172:173], v8 offset:6144
    ds_read_b64_tr_b16 v[174:175], v8 offset:7168
    ds_read_b128 v[144:147], v14 offset:4096
    ds_read_b64_tr_b16 v[176:177], v8 offset:8192
    ds_read_b64_tr_b16 v[178:179], v8 offset:9216
    s_waitcnt lgkmcnt(12)
    v_mfma_f32_32x32x16_bf16 v[64:79], v[160:163], v[128:131], 0
    ds_read_b128 v[148:151], v14 offset:5120
    ds_read_b64_tr_b16 v[180:181], v8 offset:10240
    ds_read_b64_tr_b16 v[182:183], v8 offset:11264
    s_waitcnt lgkmcnt(12)
    v_mfma_f32_32x32x16_bf16 v[64:79], v[164:167], v[132:135], v[64:79]
    ds_read_b128 v[152:155], v14 offset:6144
    ds_read_b64_tr_b16 v[184:185], v8 offset:12288
    ds_read_b64_tr_b16 v[186:187], v8 offset:13312
    s_waitcnt lgkmcnt(12)
    v_mfma_f32_32x32x16_bf16 v[64:79], v[168:171], v[136:139], v[64:79]
    ds_read_b128 v[156:159], v14 offset:7168
    ds_read_b64_tr_b16 v[188:189], v8 offset:14336
    ds_read_b64_tr_b16 v[190:191], v8 offset:15360
    s_waitcnt lgkmcnt(12)
    v_mfma_f32_32x32x16_bf16 v[64:79], v[172:175], v[140:143], v[64:79]
    ds_read_b128 v[128:131], v14 offset:8192
    ds_read_b64_tr_b16 v[160:161], v8 offset:16384
    ds_read_b64_tr_b16 v[162:163], v8 offset:17408
    s_waitcnt lgkmcnt(12)
    v_mfma_f32_32x32x16_bf16 v[64:79], v[176:179], v[144:147], v[64:79]
    ds_read_b128 v[132:135], v14 offset:9216
    ds_read_b64_tr_b16 v[164:165], v8 offset:18432
    ds_read_b64_tr_b16 v[166:167], v8 offset:19456
    s_waitcnt lgkmcnt(12)
    v_mfma_f32_32x32x16_bf16 v[64:79], v[180:183], v[148:151], v[64:79]
    ds_read_b128 v[136:139], v14 offset:10240
    ds_read_b64_tr_b16 v[168:169], v8 offset:20480
    ds_read_b64_tr_b16 v[170:171], v8 offset:21504
    s_waitcnt lgkmcnt(12)
    v_mfma_f32_32x32x16_bf16 v[64:79], v[184:187], v[152:155], v[64:79]
    ds_read_b128 v[140:143], v14 offset:11264
    ds_read_b64_tr_b16 v[172:173], v8 offset:22528
    ds_read_b64_tr_b16 v[174:175], v8 offset:23552
    s_waitcnt lgkmcnt(12)
    v_mfma_f32_32x32x16_bf16 v[64:79], v[188:191], v[156:159], v[64:79]
    ds_read_b128 v[144:147], v14 offset:12288
    ds_read_b64_tr_b16 v[176:177], v8 offset:24576
    ds_read_b64_tr_b16 v[178:179], v8 offset:25600
    s_waitcnt lgkmcnt(12)
    v_mfma_f32_32x32x16_bf16 v[64:79], v[160:163], v[128:131], v[64:79]
    ds_read_b128 v[148:151], v14 offset:13312
    ds_read_b64_tr_b16 v[180:181], v8 offset:26624
    ds_read_b64_tr_b16 v[182:183], v8 offset:27648
    s_waitcnt lgkmcnt(12)
    v_mfma_f32_32x32x16_bf16 v[64:79], v[164:167], v[132:135], v[64:79]
    ds_read_b128 v[152:155], v14 offset:14336
    ds_read_b64_tr_b16 v[184:185], v8 offset:28672
    ds_read_b64_tr_b16 v[186:187], v8 offset:29696
    s_waitcnt lgkmcnt(12)
    v_mfma_f32_32x32x16_bf16 v[64:79], v[168:171], v[136:139], v[64:79]
    ds_read_b128 v[156:159], v14 offset:15360
    ds_read_b64_tr_b16 v[188:189], v8 offset:30720
    ds_read_b64_tr_b16 v[190:191], v8 offset:31744
    s_waitcnt lgkmcnt(12)
    v_mfma_f32_32x32x16_bf16 v[64:79], v[172:175], v[140:143], v[64:79]
    ds_read_b128 v[128:131], v14 offset:16384
    ds_read_b64_tr_b16 v[160:161], v8 offset:32768
    ds_read_b64_tr_b16 v[162:163], v8 offset:33792
    s_waitcnt lgkmcnt(12)
    v_mfma_f32_32x32x16_bf16 v[64:79], v[176:179], v[144:147], v[64:79]
    ds_read_b128 v[132:135], v14 offset:17408
    ds_read_b64_tr_b16 v[164:165], v8 offset:34816
    ds_read_b64_tr_b16 v[166:167], v8 offset:35840
    s_waitcnt lgkmcnt(12)
    v_mfma_f32_32x32x16_bf16 v[64:79], v[180:183], v[148:151], v[64:79]
    ds_read_b128 v[136:139], v14 offset:18432
    ds_read_b64_tr_b16 v[168:169], v8 offset:36864
    ds_read_b64_tr_b16 v[170:171], v8 offset:37888
    v_mov_b32 v50, 39
    s_waitcnt vmcnt(0)
    ds_write_b32 v5, v50
    s_waitcnt lgkmcnt(12)
    v_mfma_f32_32x32x16_bf16 v[64:79], v[184:187], v[152:155], v[64:79]
    ds_read_b128 v[140:143], v14 offset:19456
    ds_read_b64_tr_b16 v[172:173], v8 offset:38912
    ds_read_b64_tr_b16 v[174:175], v8 offset:39936
    s_waitcnt lgkmcnt(12)
    v_mfma_f32_32x32x16_bf16 v[64:79], v[188:191], v[156:159], v[64:79]
    ds_read_b128 v[144:147], v14 offset:20480
    ds_read_b64_tr_b16 v[176:177], v8 offset:40960
    ds_read_b64_tr_b16 v[178:179], v8 offset:41984
    s_waitcnt lgkmcnt(12)
    v_mfma_f32_32x32x16_bf16 v[64:79], v[160:163], v[128:131], v[64:79]
    ds_read_b128 v[148:151], v14 offset:21504
    ds_read_b64_tr_b16 v[180:181], v8 offset:43008
    ds_read_b64_tr_b16 v[182:183], v8 offset:44032
    s_waitcnt lgkmcnt(12)
    v_mfma_f32_32x32x16_bf16 v[64:79], v[164:167], v[132:135], v[64:79]
    ds_read_b128 v[152:155], v14 offset:22528
    ds_read_b64_tr_b16 v[184:185], v8 offset:45056
    ds_read_b64_tr_b16 v[186:187], v8 offset:46080
    s_waitcnt lgkmcnt(12)
    v_mfma_f32_32x32x16_bf16 v[64:79], v[168:171], v[136:139], v[64:79]
    ds_read_b128 v[156:159], v14 offset:23552
    ds_read_b64_tr_b16 v[188:189], v8 offset:47104
    ds_read_b64_tr_b16 v[190:191], v8 offset:48128
    s_waitcnt lgkmcnt(12)
    v_mfma_f32_32x32x16_bf16 v[64:79], v[172:175], v[140:143], v[64:79]
    ds_read_b128 v[128:131], v14 offset:24576
    ds_read_b64_tr_b16 v[160:161], v8 offset:49152
    ds_read_b64_tr_b16 v[162:163], v8 offset:50176
    s_waitcnt lgkmcnt(12)
    v_mfma_f32_32x32x16_bf16 v[64:79], v[176:179], v[144:147], v[64:79]
    ds_read_b128 v[132:135], v14 offset:25600
    ds_read_b64_tr_b16 v[164:165], v8 offset:51200
    ds_read_b64_tr_b16 v[166:167], v8 offset:52224
    s_waitcnt lgkmcnt(12)
    v_mfma_f32_32x32x16_bf16 v[64:79], v[180:183], v[148:151], v[64:79]
    ds_read_b128 v[136:139], v14 offset:26624
    ds_read_b64_tr_b16 v[168:169], v8 offset:53248
    ds_read_b64_tr_b16 v[170:171], v8 offset:54272
    s_waitcnt lgkmcnt(12)
    v_mfma_f32_32x32x16_bf16 v[64:79], v[184:187], v[152:155], v[64:79]
    ds_read_b128 v[140:143], v14 offset:27648
    ds_read_b64_tr_b16 v[172:173], v8 offset:55296
    ds_read_b64_tr_b16 v[174:175], v8 offset:56320
    s_waitcnt lgkmcnt(12)
    v_mfma_f32_32x32x16_bf16 v[64:79], v[188:191], v[156:159], v[64:79]
    ds_read_b128 v[144:147], v14 offset:28672
    ds_read_b64_tr_b16 v[176:177], v8 offset:57344
    ds_read_b64_tr_b16 v[178:179], v8 offset:58368
    s_waitcnt lgkmcnt(12)
    v_mfma_f32_32x32x16_bf16 v[64:79], v[160:163], v[128:131], v[64:79]
    ds_read_b128 v[148:151], v14 offset:29696
    ds_read_b64_tr_b16 v[180:181], v8 offset:59392
    ds_read_b64_tr_b16 v[182:183], v8 offset:60416
    s_waitcnt lgkmcnt(12)
    v_mfma_f32_32x32x16_bf16 v[64:79], v[164:167], v[132:135], v[64:79]
    ds_read_b128 v[152:155], v14 offset:30720
    ds_read_b64_tr_b16 v[184:185], v8 offset:61440
    ds_read_b64_tr_b16 v[186:187], v8 offset:62464
    s_waitcnt lgkmcnt(12)
    v_mfma_f32_32x32x16_bf16 v[64:79], v[168:171], v[136:139], v[64:79]
    ds_read_b128 v[156:159], v14 offset:31744
    ds_read_b64_tr_b16 v[188:189], v8 offset:63488
    ds_read_b64_tr_b16 v[190:191], v8 offset:64512
    s_waitcnt lgkmcnt(12)
    v_mfma_f32_32x32x16_bf16 v[64:79], v[172:175], v[140:143], v[64:79]
    s_waitcnt lgkmcnt(9)
    v_mfma_f32_32x32x16_bf16 v[64:79], v[176:179], v[144:147], v[64:79]
    s_waitcnt lgkmcnt(6)
    v_mfma_f32_32x32x16_bf16 v[64:79], v[180:183], v[148:151], v[64:79]
    s_waitcnt lgkmcnt(3)
    v_mfma_f32_32x32x16_bf16 v[64:79], v[184:187], v[152:155], v[64:79]
    s_waitcnt lgkmcnt(0)
    v_mfma_f32_32x32x16_bf16 v[64:79], v[188:191], v[156:159], v[64:79]
    s_mov_b32 s35, 39
    s_add_u32 s38, s56, 16384
    s_addc_u32 s39, s57, 0
    s_nop 7
    s_nop 0
    v_cvt_pk_bf16_f32 v32, v64, v65
    v_cvt_pk_bf16_f32 v33, v66, v67
    v_cvt_pk_bf16_f32 v34, v68, v69
    v_cvt_pk_bf16_f32 v35, v70, v71
    ds_write_b128 v57, v[32:35]
    v_cvt_pk_bf16_f32 v36, v72, v73
    v_cvt_pk_bf16_f32 v37, v74, v75
    v_cvt_pk_bf16_f32 v38, v76, v77
    v_cvt_pk_bf16_f32 v39, v78, v79
    ds_write_b128 v58, v[36:39]
    s_add_u32 s35, s35, 1
    v_mov_b32 v50, s35
    ds_write_b32 v5, v50
    s_mov_b32 s46, 0
L_sb_31:
    ds_read_b32 v50, v6 offset:0
    s_waitcnt lgkmcnt(0)
    v_cmp_gt_u32 vcc, s35, v50
    s_add_u32 s46, s46, 1
    s_cmp_eq_u64 vcc, 0
    s_cbranch_scc1 L_sbd_32
    s_cmp_lt_u32 s46, 1600000
    s_cbranch_scc1 L_sb_31
L_sbd_32:
    ds_read_b128 v[40:43], v59
    ds_read_b128 v[44:47], v59 offset:1024
    s_mov_b32 s46, 0
L_sb_33:
    ds_read_b32 v50, v6 offset:16
    s_waitcnt lgkmcnt(0)
    v_cmp_gt_u32 vcc, 40, v50
    s_add_u32 s46, s46, 1
    s_cmp_eq_u64 vcc, 0
    s_cbranch_scc1 L_sbd_34
    s_sleep 1
    s_cmp_lt_u32 s46, 1600000
    s_cbranch_scc1 L_sb_33
L_sbd_34:
    s_waitcnt lgkmcnt(1)
    global_store_dwordx4 v2, v[40:43], s[56:57] sc1
    s_waitcnt lgkmcnt(0)
    global_store_dwordx4 v2, v[44:47], s[38:39] sc1
    s_barrier
    s_branch L_fin
L_bodyB:
    s_setprio 0
    s_mov_b64 exec, 0xffff
    global_load_dwordx4 v[88:91], v10, s[62:63] sc1
    s_mov_b64 exec, -1
    s_add_u32 s36, s34, 0
    s_and_b32 s36, s36, 7
    s_lshl_b32 s37, s36, 7
    s_add_u32 s37, s37, s6
    s_add_u32 s38, s18, s37
    s_addc_u32 s39, s19, 0
    s_add_u32 m0, s4, 0
    s_waitcnt vmcnt(3)
    global_load_lds_dwordx4 v26, s[38:39]
    s_add_u32 m0, s4, 1024
    s_waitcnt vmcnt(3)
    global_load_lds_dwordx4 v27, s[38:39]
    s_waitcnt vmcnt(2)
    s_setprio 3
    s_mov_b64 exec, 0xffff
    v_cmp_ne_u32 vcc, s32, v88
    v_cmp_ne_u32 s[48:49], s32, v89
    s_or_b64 vcc, vcc, s[48:49]
    v_cmp_ne_u32 s[48:49], s32, v90
    s_or_b64 vcc, vcc, s[48:49]
    v_cmp_ne_u32 s[48:49], s32, v91
    s_or_b64 vcc, vcc, s[48:49]
    s_cmp_eq_u64 vcc, 0
    s_cbranch_scc1 L_b_56
    s_mov_b32 s46, 0
L_poll_57:
    global_load_dwordx4 v[88:91], v10, s[62:63] sc1
    s_add_u32 s46, s46, 1
    s_waitcnt vmcnt(0)
    v_cmp_ne_u32 vcc, s32, v88
    v_cmp_ne_u32 s[48:49], s32, v89
    s_or_b64 vcc, vcc, s[48:49]
    v_cmp_ne_u32 s[48:49], s32, v90
    s_or_b64 vcc, vcc, s[48:49]
    v_cmp_ne_u32 s[48:49], s32, v91
    s_or_b64 vcc, vcc, s[48:49]
    s_cmp_eq_u64 vcc, 0
    s_cbranch_scc1 L_polld_58
    s_sleep 4
    s_cmp_lt_u32 s46, 200000
    s_cbranch_scc1 L_poll_57
L_polld_58:
L_b_56:
    s_mov_b64 exec, -1
    ds_write_b32 v5, v25 offset:48
    s_setprio 0
    s_mul_i32 s36, s36, 196608
    s_add_u32 s36, s36, s7
    s_lshl_b32 s37, s50, 10
    s_add_u32 s36, s36, s37
    s_add_u32 s36, s36, 1024
    s_add_u32 s38, s20, s36
    s_addc_u32 s39, s21, 0
    s_add_u32 m0, s5, 65536
    s_waitcnt vmcnt(3)
    global_load_lds_dwordx4 v240, s[38:39]
    s_add_u32 m0, s5, 66560
    s_waitcnt vmcnt(3)
    global_load_lds_dwordx4 v241, s[38:39]
    s_add_u32 m0, s5, 67584
    s_waitcnt vmcnt(3)
    global_load_lds_dwordx4 v242, s[38:39]
    s_add_u32 m0, s5, 68608
    s_waitcnt vmcnt(3)
    global_load_lds_dwordx4 v243, s[38:39]
    s_add_u32 s36, s34, 1
    s_and_b32 s36, s36, 7
    s_lshl_b32 s37, s36, 7
    s_add_u32 s37, s37, s6
    s_add_u32 s38, s18, s37
    s_addc_u32 s39, s19, 0
    s_add_u32 m0, s4, 8192
    s_waitcnt vmcnt(3)
    global_load_lds_dwordx4 v26, s[38:39]
    s_add_u32 m0, s4, 9216
    s_waitcnt vmcnt(3)
    global_load_lds_dwordx4 v27, s[38:39]
    s_mul_i32 s36, s36, 196608
    s_add_u32 s36, s36, s7
    s_lshl_b32 s37, s50, 10
    s_add_u32 s36, s36, s37
    s_add_u32 s36, s36, 1024
    s_add_u32 s38, s20, s36
    s_addc_u32 s39, s21, 0
    s_add_u32 m0, s5, 81920
    s_waitcnt vmcnt(3)
    global_load_lds_dwordx4 v240, s[38:39]
    s_add_u32 m0, s5, 82944
    s_waitcnt vmcnt(3)
    global_load_lds_dwordx4 v241, s[38:39]
    s_add_u32 m0, s5, 83968
    s_waitcnt vmcnt(3)
    global_load_lds_dwordx4 v242, s[38:39]
    s_add_u32 m0, s5, 84992
    s_waitcnt vmcnt(3)
    global_load_lds_dwordx4 v243, s[38:39]
    s_waitcnt vmcnt(6)
    s_setprio 3
    s_add_u32 s35, s35, 1
    v_mov_b32 v20, s35
    ds_write_b32 v5, v20
    s_add_u32 s36, s34, 2
    s_and_b32 s36, s36, 7
    s_lshl_b32 s37, s36, 7
    s_add_u32 s37, s37, s6
    s_add_u32 s38, s18, s37
    s_addc_u32 s39, s19, 0
    s_add_u32 m0, s4, 16384
    s_waitcnt vmcnt(3)
    global_load_lds_dwordx4 v26, s[38:39]
    s_add_u32 m0, s4, 17408
    s_waitcnt vmcnt(3)
    global_load_lds_dwordx4 v27, s[38:39]
    s_mul_i32 s36, s36, 196608
    s_add_u32 s36, s36, s7
    s_lshl_b32 s37, s50, 10
    s_add_u32 s36, s36, s37
    s_add_u32 s36, s36, 1024
    s_add_u32 s38, s20, s36
    s_addc_u32 s39, s21, 0
    s_add_u32 m0, s5, 98304
    s_waitcnt vmcnt(3)
    global_load_lds_dwordx4 v240, s[38:39]
    s_add_u32 m0, s5, 99328
    s_waitcnt vmcnt(3)
    global_load_lds_dwordx4 v241, s[38:39]
    s_add_u32 m0, s5, 100352
    s_waitcnt vmcnt(3)
    global_load_lds_dwordx4 v242, s[38:39]
    s_add_u32 m0, s5, 101376
    s_waitcnt vmcnt(3)
    global_load_lds_dwordx4 v243, s[38:39]
    s_mov_b32 s46, 0
L_sb_59:
    ds_read_b32 v21, v6 offset:0
    s_waitcnt lgkmcnt(0)
    v_cmp_gt_u32 vcc, s35, v21
    s_add_u32 s46, s46, 1
    s_cmp_eq_u64 vcc, 0
    s_cbranch_scc1 L_sbd_60
    s_sleep 1
    s_cmp_lt_u32 s46, 1600000
    s_cbranch_scc1 L_sb_59
L_sbd_60:
    ds_read_b128 v[96:99], v244 offset:0
    ds_read_b64_tr_b16 v[100:101], v248 offset:0
    ds_read_b64_tr_b16 v[102:103], v248 offset:256
    ds_read_b64_tr_b16 v[104:105], v248 offset:8192
    ds_read_b64_tr_b16 v[106:107], v248 offset:8448
    ds_read_b128 v[108:111], v245 offset:0
    ds_read_b64_tr_b16 v[112:113], v248 offset:2048
    ds_read_b64_tr_b16 v[114:115], v248 offset:2304
    ds_read_b64_tr_b16 v[116:117], v248 offset:10240
    ds_read_b64_tr_b16 v[118:119], v248 offset:10496
    ds_read_b128 v[120:123], v246 offset:0
    ds_read_b64_tr_b16 v[124:125], v248 offset:4096
    ds_read_b64_tr_b16 v[126:127], v248 offset:4352
    ds_read_b64_tr_b16 v[128:129], v248 offset:12288
    ds_read_b64_tr_b16 v[130:131], v248 offset:12544
    ds_read_b128 v[132:135], v247 offset:0
    ds_read_b64_tr_b16 v[136:137], v248 offset:6144
    ds_read_b64_tr_b16 v[138:139], v248 offset:6400
    ds_read_b64_tr_b16 v[140:141], v248 offset:14336
    ds_read_b64_tr_b16 v[142:143], v248 offset:14592
    s_waitcnt vmcnt(6)
    s_add_u32 s35, s35, 1
    v_mov_b32 v20, s35
    ds_write_b32 v5, v20
    s_setprio 0
    s_add_u32 s36, s34, 3
    s_and_b32 s36, s36, 7
    s_lshl_b32 s37, s36, 7
    s_add_u32 s37, s37, s6
    s_add_u32 s38, s18, s37
    s_addc_u32 s39, s19, 0
    s_add_u32 m0, s4, 24576
    s_waitcnt vmcnt(3)
    global_load_lds_dwordx4 v26, s[38:39]
    s_add_u32 m0, s4, 25600
    s_waitcnt vmcnt(3)
    global_load_lds_dwordx4 v27, s[38:39]
    s_mul_i32 s36, s36, 196608
    s_add_u32 s36, s36, s7
    s_lshl_b32 s37, s50, 10
    s_add_u32 s36, s36, s37
    s_add_u32 s36, s36, 1024
    s_add_u32 s38, s20, s36
    s_addc_u32 s39, s21, 0
    s_add_u32 m0, s5, 114688
    s_waitcnt vmcnt(3)
    global_load_lds_dwordx4 v240, s[38:39]
    s_add_u32 m0, s5, 115712
    s_waitcnt vmcnt(3)
    global_load_lds_dwordx4 v241, s[38:39]
    s_add_u32 m0, s5, 116736
    s_waitcnt vmcnt(3)
    global_load_lds_dwordx4 v242, s[38:39]
    s_add_u32 m0, s5, 117760
    s_waitcnt vmcnt(3)
    global_load_lds_dwordx4 v243, s[38:39]
    s_waitcnt lgkmcnt(14)
    v_mfma_f32_32x32x16_bf16 v[32:47], v[96:99], v[100:103], v[32:47]
    ds_read_b32 v21, v6
    s_add_u32 s36, s34, 4
    s_and_b32 s36, s36, 7
    s_lshl_b32 s37, s36, 7
    s_add_u32 s37, s37, s6
    s_add_u32 s38, s18, s37
    s_addc_u32 s39, s19, 0
    s_waitcnt lgkmcnt(0)
    v_mfma_f32_32x32x16_bf16 v[48:63], v[96:99], v[104:107], 0
    s_waitcnt lgkmcnt(0)
    s_setprio 3
    v_cmp_gt_u32 vcc, s35, v21
    s_cbranch_vccz L_ok_61
    s_mov_b32 s46, 0
L_sb_62:
    ds_read_b32 v21, v6 offset:0
    s_waitcnt lgkmcnt(0)
    v_cmp_gt_u32 vcc, s35, v21
    s_add_u32 s46, s46, 1
    s_cmp_eq_u64 vcc, 0
    s_cbranch_scc1 L_sbd_63
    s_sleep 1
    s_cmp_lt_u32 s46, 1600000
    s_cbranch_scc1 L_sb_62
L_sbd_63:
L_ok_61:
    s_setprio 0
    ds_read_b128 v[160:163], v244 offset:8192
    ds_read_b64_tr_b16 v[164:165], v248 offset:16384
    ds_read_b64_tr_b16 v[166:167], v248 offset:16640
    s_waitcnt lgkmcnt(3)
    v_mfma_f32_32x32x16_bf16 v[32:47], v[108:111], v[112:115], v[32:47]
    ds_read_b64_tr_b16 v[168:169], v248 offset:24576
    s_add_u32 m0, s4, 32768
    s_waitcnt vmcnt(4)
    global_load_lds_dwordx4 v26, s[38:39]
    ds_read_b64_tr_b16 v[170:171], v248 offset:24832
    ds_read_b128 v[172:175], v245 offset:8192
    ds_read_b64_tr_b16 v[176:177], v248 offset:18432
    s_waitcnt lgkmcnt(3)
    v_mfma_f32_32x32x16_bf16 v[48:63], v[108:111], v[116:119], v[48:63]
    s_add_u32 m0, s4, 33792
    s_waitcnt vmcnt(4)
    global_load_lds_dwordx4 v27, s[38:39]
    ds_read_b64_tr_b16 v[178:179], v248 offset:18688
    ds_read_b64_tr_b16 v[180:181], v248 offset:26624
    ds_read_b64_tr_b16 v[182:183], v248 offset:26880
    s_waitcnt lgkmcnt(3)
    v_mfma_f32_32x32x16_bf16 v[32:47], v[120:123], v[124:127], v[32:47]
    s_mul_i32 s36, s36, 196608
    s_add_u32 s36, s36, s7
    s_lshl_b32 s37, s50, 10
    s_add_u32 s36, s36, s37
    s_add_u32 s36, s36, 1024
    s_add_u32 s38, s20, s36
    s_addc_u32 s39, s21, 0
    s_add_u32 m0, s5, 65536
    s_waitcnt vmcnt(4)
    global_load_lds_dwordx4 v240, s[38:39]
    s_waitcnt lgkmcnt(3)
    v_mfma_f32_32x32x16_bf16 v[48:63], v[120:123], v[128:131], v[48:63]
    ds_read_b128 v[184:187], v246 offset:8192
    ds_read_b64_tr_b16 v[188:189], v248 offset:20480
    ds_read_b64_tr_b16 v[190:191], v248 offset:20736
    ds_read_b64_tr_b16 v[192:193], v248 offset:28672
    s_add_u32 m0, s5, 66560
    s_waitcnt vmcnt(4)
    global_load_lds_dwordx4 v241, s[38:39]
    ds_read_b64_tr_b16 v[194:195], v248 offset:28928
    s_waitcnt lgkmcnt(3)
    v_mfma_f32_32x32x16_bf16 v[32:47], v[132:135], v[136:139], v[32:47]
    ds_read_b128 v[196:199], v247 offset:8192
    ds_read_b64_tr_b16 v[200:201], v248 offset:22528
    s_add_u32 m0, s5, 67584
    s_waitcnt vmcnt(4)
    global_load_lds_dwordx4 v242, s[38:39]
    ds_read_b64_tr_b16 v[202:203], v248 offset:22784
    ds_read_b64_tr_b16 v[204:205], v248 offset:30720
    ds_read_b64_tr_b16 v[206:207], v248 offset:30976
    s_waitcnt lgkmcnt(3)
    v_mfma_f32_32x32x16_bf16 v[48:63], v[132:135], v[140:143], v[48:63]
    s_add_u32 m0, s5, 68608
    s_waitcnt vmcnt(4)
    global_load_lds_dwordx4 v243, s[38:39]
    s_waitcnt vmcnt(12)
    s_setprio 3
    s_add_u32 s35, s35, 1
    v_mov_b32 v20, s35
    ds_write_b32 v5, v20
    s_setprio 0
    s_waitcnt lgkmcnt(14)
    v_mfma_f32_32x32x16_bf16 v[32:47], v[160:163], v[164:167], v[32:47]
    ds_read_b32 v21, v6
    s_add_u32 s36, s34, 5
    s_and_b32 s36, s36, 7
    s_lshl_b32 s37, s36, 7
    s_add_u32 s37, s37, s6
    s_add_u32 s38, s18, s37
    s_addc_u32 s39, s19, 0
    s_waitcnt lgkmcnt(0)
    v_mfma_f32_32x32x16_bf16 v[48:63], v[160:163], v[168:171], v[48:63]
    s_waitcnt lgkmcnt(0)
    s_setprio 3
    v_cmp_gt_u32 vcc, s35, v21
    s_cbranch_vccz L_ok_64
    s_mov_b32 s46, 0
L_sb_65:
    ds_read_b32 v21, v6 offset:0
    s_waitcnt lgkmcnt(0)
    v_cmp_gt_u32 vcc, s35, v21
    s_add_u32 s46, s46, 1
    s_cmp_eq_u64 vcc, 0
    s_cbranch_scc1 L_sbd_66
    s_sleep 1
    s_cmp_lt_u32 s46, 1600000
    s_cbranch_scc1 L_sb_65
L_sbd_66:
L_ok_64:
    s_setprio 0
    ds_read_b128 v[96:99], v244 offset:16384
    ds_read_b64_tr_b16 v[100:101], v248 offset:32768
    ds_read_b64_tr_b16 v[102:103], v248 offset:33024
    s_waitcnt lgkmcnt(3)
    v_mfma_f32_32x32x16_bf16 v[32:47], v[172:175], v[176:179], v[32:47]
    ds_read_b64_tr_b16 v[104:105], v248 offset:40960
    s_add_u32 m0, s4, 40960
    s_waitcnt vmcnt(4)
    global_load_lds_dwordx4 v26, s[38:39]
    ds_read_b64_tr_b16 v[106:107], v248 offset:41216
    ds_read_b128 v[108:111], v245 offset:16384
    ds_read_b64_tr_b16 v[112:113], v248 offset:34816
    s_waitcnt lgkmcnt(3)
    v_mfma_f32_32x32x16_bf16 v[48:63], v[172:175], v[180:183], v[48:63]
    s_add_u32 m0, s4, 41984
    s_waitcnt vmcnt(4)
    global_load_lds_dwordx4 v27, s[38:39]
    ds_read_b64_tr_b16 v[114:115], v248 offset:35072
    ds_read_b64_tr_b16 v[116:117], v248 offset:43008
    ds_read_b64_tr_b16 v[118:119], v248 offset:43264
    s_waitcnt lgkmcnt(3)
    v_mfma_f32_32x32x16_bf16 v[32:47], v[184:187], v[188:191], v[32:47]
    s_mul_i32 s36, s36, 196608
    s_add_u32 s36, s36, s7
    s_lshl_b32 s37, s50, 10
    s_add_u32 s36, s36, s37
    s_add_u32 s36, s36, 1024
    s_add_u32 s38, s20, s36
    s_addc_u32 s39, s21, 0
    s_add_u32 m0, s5, 81920
    s_waitcnt vmcnt(4)
    global_load_lds_dwordx4 v240, s[38:39]
    s_waitcnt lgkmcnt(3)
    v_mfma_f32_32x32x16_bf16 v[48:63], v[184:187], v[192:195], v[48:63]
    ds_read_b128 v[120:123], v246 offset:16384
    ds_read_b64_tr_b16 v[124:125], v248 offset:36864
    ds_read_b64_tr_b16 v[126:127], v248 offset:37120
    ds_read_b64_tr_b16 v[128:129], v248 offset:45056
    s_add_u32 m0, s5, 82944
    s_waitcnt vmcnt(4)
    global_load_lds_dwordx4 v241, s[38:39]
    ds_read_b64_tr_b16 v[130:131], v248 offset:45312
    s_waitcnt lgkmcnt(3)
    v_mfma_f32_32x32x16_bf16 v[32:47], v[196:199], v[200:203], v[32:47]
    ds_read_b128 v[132:135], v247 offset:16384
    ds_read_b64_tr_b16 v[136:137], v248 offset:38912
    s_add_u32 m0, s5, 83968
    s_waitcnt vmcnt(4)
    global_load_lds_dwordx4 v242, s[38:39]
    ds_read_b64_tr_b16 v[138:139], v248 offset:39168
    ds_read_b64_tr_b16 v[140:141], v248 offset:47104
    ds_read_b64_tr_b16 v[142:143], v248 offset:47360
    s_waitcnt lgkmcnt(3)
    v_mfma_f32_32x32x16_bf16 v[48:63], v[196:199], v[204:207], v[48:63]
    s_add_u32 m0, s5, 84992
    s_waitcnt vmcnt(4)
    global_load_lds_dwordx4 v243, s[38:39]
    s_waitcnt vmcnt(12)
    s_setprio 3
    s_add_u32 s35, s35, 1
    v_mov_b32 v20, s35
    ds_write_b32 v5, v20
    s_setprio 0
    s_waitcnt lgkmcnt(14)
    v_mfma_f32_32x32x16_bf16 v[32:47], v[96:99], v[100:103], v[32:47]
    ds_read_b32 v21, v6
    s_add_u32 s36, s34, 6
    s_and_b32 s36, s36, 7
    s_lshl_b32 s37, s36, 7
    s_add_u32 s37, s37, s6
    s_add_u32 s38, s18, s37
    s_addc_u32 s39, s19, 0
    s_waitcnt lgkmcnt(0)
    v_mfma_f32_32x32x16_bf16 v[48:63], v[96:99], v[104:107], v[48:63]
    s_waitcnt lgkmcnt(0)
    s_setprio 3
    v_cmp_gt_u32 vcc, s35, v21
    s_cbranch_vccz L_ok_67
    s_mov_b32 s46, 0
L_sb_68:
    ds_read_b32 v21, v6 offset:0
    s_waitcnt lgkmcnt(0)
    v_cmp_gt_u32 vcc, s35, v21
    s_add_u32 s46, s46, 1
    s_cmp_eq_u64 vcc, 0
    s_cbranch_scc1 L_sbd_69
    s_sleep 1
    s_cmp_lt_u32 s46, 1600000
    s_cbranch_scc1 L_sb_68
L_sbd_69:
L_ok_67:
    s_setprio 0
    ds_read_b128 v[160:163], v244 offset:24576
    ds_read_b64_tr_b16 v[164:165], v248 offset:49152
    ds_read_b64_tr_b16 v[166:167], v248 offset:49408
    s_waitcnt lgkmcnt(3)
    v_mfma_f32_32x32x16_bf16 v[32:47], v[108:111], v[112:115], v[32:47]
    ds_read_b64_tr_b16 v[168:169], v248 offset:57344
    s_add_u32 m0, s4, 49152
    s_waitcnt vmcnt(4)
    global_load_lds_dwordx4 v26, s[38:39]
    ds_read_b64_tr_b16 v[170:171], v248 offset:57600
    ds_read_b128 v[172:175], v245 offset:24576
    ds_read_b64_tr_b16 v[176:177], v248 offset:51200
    s_waitcnt lgkmcnt(3)
    v_mfma_f32_32x32x16_bf16 v[48:63], v[108:111], v[116:119], v[48:63]
    s_add_u32 m0, s4, 50176
    s_waitcnt vmcnt(4)
    global_load_lds_dwordx4 v27, s[38:39]
    ds_read_b64_tr_b16 v[178:179], v248 offset:51456
    ds_read_b64_tr_b16 v[180:181], v248 offset:59392
    ds_read_b64_tr_b16 v[182:183], v248 offset:59648
    s_waitcnt lgkmcnt(3)
    v_mfma_f32_32x32x16_bf16 v[32:47], v[120:123], v[124:127], v[32:47]
    s_mul_i32 s36, s36, 196608
    s_add_u32 s36, s36, s7
    s_lshl_b32 s37, s50, 10
    s_add_u32 s36, s36, s37
    s_add_u32 s36, s36, 1024
    s_add_u32 s38, s20, s36
    s_addc_u32 s39, s21, 0
    s_add_u32 m0, s5, 98304
    s_waitcnt vmcnt(4)
    global_load_lds_dwordx4 v240, s[38:39]
    s_waitcnt lgkmcnt(3)
    v_mfma_f32_32x32x16_bf16 v[48:63], v[120:123], v[128:131], v[48:63]
    ds_read_b128 v[184:187], v246 offset:24576
    ds_read_b64_tr_b16 v[188:189], v248 offset:53248
    ds_read_b64_tr_b16 v[190:191], v248 offset:53504
    ds_read_b64_tr_b16 v[192:193], v248 offset:61440
    s_add_u32 m0, s5, 99328
    s_waitcnt vmcnt(4)
    global_load_lds_dwordx4 v241, s[38:39]
    ds_read_b64_tr_b16 v[194:195], v248 offset:61696
    s_waitcnt lgkmcnt(3)
    v_mfma_f32_32x32x16_bf16 v[32:47], v[132:135], v[136:139], v[32:47]
    ds_read_b128 v[196:199], v247 offset:24576
    ds_read_b64_tr_b16 v[200:201], v248 offset:55296
    s_add_u32 m0, s5, 100352
    s_waitcnt vmcnt(4)
    global_load_lds_dwordx4 v242, s[38:39]
    ds_read_b64_tr_b16 v[202:203], v248 offset:55552
    ds_read_b64_tr_b16 v[204:205], v248 offset:63488
    ds_read_b64_tr_b16 v[206:207], v248 offset:63744
    s_waitcnt lgkmcnt(3)
    v_mfma_f32_32x32x16_bf16 v[48:63], v[132:135], v[140:143], v[48:63]
    s_add_u32 m0, s5, 101376
    s_waitcnt vmcnt(4)
    global_load_lds_dwordx4 v243, s[38:39]
    s_waitcnt vmcnt(12)
    s_setprio 3
    s_add_u32 s35, s35, 1
    v_mov_b32 v20, s35
    ds_write_b32 v5, v20
    s_setprio 0
    s_waitcnt lgkmcnt(14)
    v_mfma_f32_32x32x16_bf16 v[32:47], v[160:163], v[164:167], v[32:47]
    ds_read_b32 v21, v6
    s_add_u32 s36, s34, 7
    s_and_b32 s36, s36, 7
    s_lshl_b32 s37, s36, 7
    s_add_u32 s37, s37, s6
    s_add_u32 s38, s18, s37
    s_addc_u32 s39, s19, 0
    s_waitcnt lgkmcnt(0)
    v_mfma_f32_32x32x16_bf16 v[48:63], v[160:163], v[168:171], v[48:63]
    s_waitcnt lgkmcnt(0)
    s_setprio 3
    v_cmp_gt_u32 vcc, s35, v21
    s_cbranch_vccz L_ok_70
    s_mov_b32 s46, 0
L_sb_71:
    ds_read_b32 v21, v6 offset:0
    s_waitcnt lgkmcnt(0)
    v_cmp_gt_u32 vcc, s35, v21
    s_add_u32 s46, s46, 1
    s_cmp_eq_u64 vcc, 0
    s_cbranch_scc1 L_sbd_72
    s_sleep 1
    s_cmp_lt_u32 s46, 1600000
    s_cbranch_scc1 L_sb_71
L_sbd_72:
L_ok_70:
    s_setprio 0
    ds_read_b128 v[96:99], v244 offset:32768
    ds_read_b64_tr_b16 v[100:101], v248 offset:0
    ds_read_b64_tr_b16 v[102:103], v248 offset:256
    s_waitcnt lgkmcnt(3)
    v_mfma_f32_32x32x16_bf16 v[32:47], v[172:175], v[176:179], v[32:47]
    ds_read_b64_tr_b16 v[104:105], v248 offset:8192
    s_add_u32 m0, s4, 57344
    s_waitcnt vmcnt(4)
    global_load_lds_dwordx4 v26, s[38:39]
    ds_read_b64_tr_b16 v[106:107], v248 offset:8448
    ds_read_b128 v[108:111], v245 offset:32768
    ds_read_b64_tr_b16 v[112:113], v248 offset:2048
    s_waitcnt lgkmcnt(3)
    v_mfma_f32_32x32x16_bf16 v[48:63], v[172:175], v[180:183], v[48:63]
    s_add_u32 m0, s4, 58368
    s_waitcnt vmcnt(4)
    global_load_lds_dwordx4 v27, s[38:39]
    ds_read_b64_tr_b16 v[114:115], v248 offset:2304
    ds_read_b64_tr_b16 v[116:117], v248 offset:10240
    ds_read_b64_tr_b16 v[118:119], v248 offset:10496
    s_waitcnt lgkmcnt(3)
    v_mfma_f32_32x32x16_bf16 v[32:47], v[184:187], v[188:191], v[32:47]
    s_mul_i32 s36, s36, 196608
    s_add_u32 s36, s36, s7
    s_lshl_b32 s37, s50, 10
    s_add_u32 s36, s36, s37
    s_add_u32 s36, s36, 1024
    s_add_u32 s38, s20, s36
    s_addc_u32 s39, s21, 0
    s_add_u32 m0, s5, 114688
    s_waitcnt vmcnt(4)
    global_load_lds_dwordx4 v240, s[38:39]
    s_waitcnt lgkmcnt(3)
    v_mfma_f32_32x32x16_bf16 v[48:63], v[184:187], v[192:195], v[48:63]
    ds_read_b128 v[120:123], v246 offset:32768
    ds_read_b64_tr_b16 v[124:125], v248 offset:4096
    ds_read_b64_tr_b16 v[126:127], v248 offset:4352
    ds_read_b64_tr_b16 v[128:129], v248 offset:12288
    s_add_u32 m0, s5, 115712
    s_waitcnt vmcnt(4)
    global_load_lds_dwordx4 v241, s[38:39]
    ds_read_b64_tr_b16 v[130:131], v248 offset:12544
    s_waitcnt lgkmcnt(3)
    v_mfma_f32_32x32x16_bf16 v[32:47], v[196:199], v[200:203], v[32:47]
    ds_read_b128 v[132:135], v247 offset:32768
    ds_read_b64_tr_b16 v[136:137], v248 offset:6144
    s_add_u32 m0, s5, 116736
    s_waitcnt vmcnt(4)
    global_load_lds_dwordx4 v242, s[38:39]
    ds_read_b64_tr_b16 v[138:139], v248 offset:6400
    ds_read_b64_tr_b16 v[140:141], v248 offset:14336
    ds_read_b64_tr_b16 v[142:143], v248 offset:14592
    s_waitcnt lgkmcnt(3)
    v_mfma_f32_32x32x16_bf16 v[48:63], v[196:199], v[204:207], v[48:63]
    s_add_u32 m0, s5, 117760
    s_waitcnt vmcnt(4)
    global_load_lds_dwordx4 v243, s[38:39]
    s_waitcnt vmcnt(12)
    s_setprio 3
    s_add_u32 s35, s35, 1
    v_mov_b32 v20, s35
    ds_write_b32 v5, v20
    s_setprio 0
    s_waitcnt lgkmcnt(14)
    v_mfma_f32_32x32x16_bf16 v[32:47], v[96:99], v[100:103], v[32:47]
    ds_read_b32 v21, v6
    s_add_u32 s36, s34, s50
    s_add_u32 s36, s36, 0
    s_and_b32 s36, s36, 7
    s_mul_i32 s36, s36, 196608
    s_add_u32 s36, s36, s7
    s_add_u32 s38, s20, s36
    s_addc_u32 s39, s21, 0
    s_waitcnt lgkmcnt(0)
    v_mfma_f32_32x32x16_bf16 v[48:63], v[96:99], v[104:107], v[48:63]
    s_waitcnt lgkmcnt(0)
    s_setprio 3
    v_cmp_gt_u32 vcc, s35, v21
    s_cbranch_vccz L_ok_73
    s_mov_b32 s46, 0
L_sb_74:
    ds_read_b32 v21, v6 offset:0
    s_waitcnt lgkmcnt(0)
    v_cmp_gt_u32 vcc, s35, v21
    s_add_u32 s46, s46, 1
    s_cmp_eq_u64 vcc, 0
    s_cbranch_scc1 L_sbd_75
    s_sleep 1
    s_cmp_lt_u32 s46, 1600000
    s_cbranch_scc1 L_sb_74
L_sbd_75:
L_ok_73:
    s_setprio 0
    ds_read_b128 v[160:163], v244 offset:40960
    ds_read_b64_tr_b16 v[164:165], v248 offset:16384
    s_waitcnt lgkmcnt(3)
    v_mfma_f32_32x32x16_bf16 v[32:47], v[108:111], v[112:115], v[32:47]
    ds_read_b64_tr_b16 v[166:167], v248 offset:16640
    ds_read_b64_tr_b16 v[168:169], v248 offset:24576
    ds_read_b64_tr_b16 v[170:171], v248 offset:24832
    s_add_u32 m0, s5, 65536
    s_waitcnt vmcnt(4)
    global_load_lds_dwordx4 v240, s[38:39]
    s_waitcnt lgkmcnt(3)
    v_mfma_f32_32x32x16_bf16 v[48:63], v[108:111], v[116:119], v[48:63]
    ds_read_b128 v[172:175], v245 offset:40960
    ds_read_b64_tr_b16 v[176:177], v248 offset:18432
    ds_read_b64_tr_b16 v[178:179], v248 offset:18688
    ds_read_b64_tr_b16 v[180:181], v248 offset:26624
    ds_read_b64_tr_b16 v[182:183], v248 offset:26880
    s_waitcnt lgkmcnt(3)
    v_mfma_f32_32x32x16_bf16 v[32:47], v[120:123], v[124:127], v[32:47]
    s_add_u32 m0, s5, 66560
    s_waitcnt vmcnt(4)
    global_load_lds_dwordx4 v241, s[38:39]
    ds_read_b128 v[184:187], v246 offset:40960
    ds_read_b64_tr_b16 v[188:189], v248 offset:20480
    ds_read_b64_tr_b16 v[190:191], v248 offset:20736
    s_waitcnt lgkmcnt(3)
    v_mfma_f32_32x32x16_bf16 v[48:63], v[120:123], v[128:131], v[48:63]
    ds_read_b64_tr_b16 v[192:193], v248 offset:28672
    ds_read_b64_tr_b16 v[194:195], v248 offset:28928
    s_add_u32 m0, s5, 67584
    s_waitcnt vmcnt(4)
    global_load_lds_dwordx4 v242, s[38:39]
    ds_read_b128 v[196:199], v247 offset:40960
    s_waitcnt lgkmcnt(3)
    v_mfma_f32_32x32x16_bf16 v[32:47], v[132:135], v[136:139], v[32:47]
    ds_read_b64_tr_b16 v[200:201], v248 offset:22528
    ds_read_b64_tr_b16 v[202:203], v248 offset:22784
    ds_read_b64_tr_b16 v[204:205], v248 offset:30720
    ds_read_b64_tr_b16 v[206:207], v248 offset:30976
    s_add_u32 m0, s5, 68608
    s_waitcnt vmcnt(4)
    global_load_lds_dwordx4 v243, s[38:39]
    s_waitcnt lgkmcnt(3)
    v_mfma_f32_32x32x16_bf16 v[48:63], v[132:135], v[140:143], v[48:63]
    s_waitcnt vmcnt(10)
    s_setprio 3
    s_add_u32 s35, s35, 1
    v_mov_b32 v20, s35
    ds_write_b32 v5, v20
    s_setprio 0
    s_waitcnt lgkmcnt(14)
    v_mfma_f32_32x32x16_bf16 v[32:47], v[160:163], v[164:167], v[32:47]
    ds_read_b32 v21, v6
    s_add_u32 s36, s34, s50
    s_add_u32 s36, s36, 2
    s_and_b32 s36, s36, 7
    s_mul_i32 s36, s36, 196608
    s_add_u32 s36, s36, s7
    s_add_u32 s38, s20, s36
    s_addc_u32 s39, s21, 0
    s_waitcnt lgkmcnt(0)
    v_mfma_f32_32x32x16_bf16 v[48:63], v[160:163], v[168:171], v[48:63]
    s_waitcnt lgkmcnt(0)
    s_setprio 3
    v_cmp_gt_u32 vcc, s35, v21
    s_cbranch_vccz L_ok_76
    s_mov_b32 s46, 0
L_sb_77:
    ds_read_b32 v21, v6 offset:0
    s_waitcnt lgkmcnt(0)
    v_cmp_gt_u32 vcc, s35, v21
    s_add_u32 s46, s46, 1
    s_cmp_eq_u64 vcc, 0
    s_cbranch_scc1 L_sbd_78
    s_sleep 1
    s_cmp_lt_u32 s46, 1600000
    s_cbranch_scc1 L_sb_77
L_sbd_78:
L_ok_76:
    s_setprio 0
    ds_read_b128 v[96:99], v244 offset:49152
    ds_read_b64_tr_b16 v[100:101], v248 offset:32768
    s_waitcnt lgkmcnt(3)
    v_mfma_f32_32x32x16_bf16 v[32:47], v[172:175], v[176:179], v[32:47]
    ds_read_b64_tr_b16 v[102:103], v248 offset:33024
    ds_read_b64_tr_b16 v[104:105], v248 offset:40960
    ds_read_b64_tr_b16 v[106:107], v248 offset:41216
    s_add_u32 m0, s5, 81920
    s_waitcnt vmcnt(4)
    global_load_lds_dwordx4 v240, s[38:39]
    s_waitcnt lgkmcnt(3)
    v_mfma_f32_32x32x16_bf16 v[48:63], v[172:175], v[180:183], v[48:63]
    ds_read_b128 v[108:111], v245 offset:49152
    ds_read_b64_tr_b16 v[112:113], v248 offset:34816
    ds_read_b64_tr_b16 v[114:115], v248 offset:35072
    ds_read_b64_tr_b16 v[116:117], v248 offset:43008
    ds_read_b64_tr_b16 v[118:119], v248 offset:43264
    s_waitcnt lgkmcnt(3)
    v_mfma_f32_32x32x16_bf16 v[32:47], v[184:187], v[188:191], v[32:47]
    s_add_u32 m0, s5, 82944
    s_waitcnt vmcnt(4)
    global_load_lds_dwordx4 v241, s[38:39]
    ds_read_b128 v[120:123], v246 offset:49152
    ds_read_b64_tr_b16 v[124:125], v248 offset:36864
    ds_read_b64_tr_b16 v[126:127], v248 offset:37120
    s_waitcnt lgkmcnt(3)
    v_mfma_f32_32x32x16_bf16 v[48:63], v[184:187], v[192:195], v[48:63]
    ds_read_b64_tr_b16 v[128:129], v248 offset:45056
    ds_read_b64_tr_b16 v[130:131], v248 offset:45312
    s_add_u32 m0, s5, 83968
    s_waitcnt vmcnt(4)
    global_load_lds_dwordx4 v242, s[38:39]
    ds_read_b128 v[132:135], v247 offset:49152
    s_waitcnt lgkmcnt(3)
    v_mfma_f32_32x32x16_bf16 v[32:47], v[196:199], v[200:203], v[32:47]
    ds_read_b64_tr_b16 v[136:137], v248 offset:38912
    ds_read_b64_tr_b16 v[138:139], v248 offset:39168
    ds_read_b64_tr_b16 v[140:141], v248 offset:47104
    ds_read_b64_tr_b16 v[142:143], v248 offset:47360
    s_add_u32 m0, s5, 84992
    s_waitcnt vmcnt(4)
    global_load_lds_dwordx4 v243, s[38:39]
    s_waitcnt lgkmcnt(3)
    v_mfma_f32_32x32x16_bf16 v[48:63], v[196:199], v[204:207], v[48:63]
    s_waitcnt vmcnt(8)
    s_setprio 3
    s_add_u32 s35, s35, 1
    v_mov_b32 v20, s35
    ds_write_b32 v5, v20
    s_setprio 0
    s_waitcnt lgkmcnt(14)
    v_mfma_f32_32x32x16_bf16 v[32:47], v[96:99], v[100:103], v[32:47]
    ds_read_b32 v21, v6
    s_add_u32 s36, s34, s50
    s_add_u32 s36, s36, 4
    s_and_b32 s36, s36, 7
    s_mul_i32 s36, s36, 196608
    s_add_u32 s36, s36, s7
    s_add_u32 s38, s20, s36
    s_addc_u32 s39, s21, 0
    s_waitcnt lgkmcnt(0)
    v_mfma_f32_32x32x16_bf16 v[48:63], v[96:99], v[104:107], v[48:63]
    s_waitcnt lgkmcnt(0)
    s_setprio 3
    v_cmp_gt_u32 vcc, s35, v21
    s_cbranch_vccz L_ok_79
    s_mov_b32 s46, 0
L_sb_80:
    ds_read_b32 v21, v6 offset:0
    s_waitcnt lgkmcnt(0)
    v_cmp_gt_u32 vcc, s35, v21
    s_add_u32 s46, s46, 1
    s_cmp_eq_u64 vcc, 0
    s_cbranch_scc1 L_sbd_81
    s_sleep 1
    s_cmp_lt_u32 s46, 1600000
    s_cbranch_scc1 L_sb_80
L_sbd_81:
L_ok_79:
    s_setprio 0
    ds_read_b128 v[160:163], v244 offset:57344
    ds_read_b64_tr_b16 v[164:165], v248 offset:49152
    s_waitcnt lgkmcnt(3)
    v_mfma_f32_32x32x16_bf16 v[32:47], v[108:111], v[112:115], v[32:47]
    ds_read_b64_tr_b16 v[166:167], v248 offset:49408
    ds_read_b64_tr_b16 v[168:169], v248 offset:57344
    ds_read_b64_tr_b16 v[170:171], v248 offset:57600
    s_add_u32 m0, s5, 98304
    s_waitcnt vmcnt(4)
    global_load_lds_dwordx4 v240, s[38:39]
    s_waitcnt lgkmcnt(3)
    v_mfma_f32_32x32x16_bf16 v[48:63], v[108:111], v[116:119], v[48:63]
    ds_read_b128 v[172:175], v245 offset:57344
    ds_read_b64_tr_b16 v[176:177], v248 offset:51200
    ds_read_b64_tr_b16 v[178:179], v248 offset:51456
    ds_read_b64_tr_b16 v[180:181], v248 offset:59392
    ds_read_b64_tr_b16 v[182:183], v248 offset:59648
    s_waitcnt lgkmcnt(3)
    v_mfma_f32_32x32x16_bf16 v[32:47], v[120:123], v[124:127], v[32:47]
    s_add_u32 m0, s5, 99328
    s_waitcnt vmcnt(4)
    global_load_lds_dwordx4 v241, s[38:39]
    ds_read_b128 v[184:187], v246 offset:57344
    ds_read_b64_tr_b16 v[188:189], v248 offset:53248
    ds_read_b64_tr_b16 v[190:191], v248 offset:53504
    s_waitcnt lgkmcnt(3)
    v_mfma_f32_32x32x16_bf16 v[48:63], v[120:123], v[128:131], v[48:63]
    ds_read_b64_tr_b16 v[192:193], v248 offset:61440
    ds_read_b64_tr_b16 v[194:195], v248 offset:61696
    s_add_u32 m0, s5, 100352
    s_waitcnt vmcnt(4)
    global_load_lds_dwordx4 v242, s[38:39]
    ds_read_b128 v[196:199], v247 offset:57344
    s_waitcnt lgkmcnt(3)
    v_mfma_f32_32x32x16_bf16 v[32:47], v[132:135], v[136:139], v[32:47]
    ds_read_b64_tr_b16 v[200:201], v248 offset:55296
    ds_read_b64_tr_b16 v[202:203], v248 offset:55552
    ds_read_b64_tr_b16 v[204:205], v248 offset:63488
    ds_read_b64_tr_b16 v[206:207], v248 offset:63744
    s_add_u32 m0, s5, 101376
    s_waitcnt vmcnt(4)
    global_load_lds_dwordx4 v243, s[38:39]
    s_waitcnt lgkmcnt(3)
    v_mfma_f32_32x32x16_bf16 v[48:63], v[132:135], v[140:143], v[48:63]
    s_waitcnt vmcnt(8)
    s_setprio 3
    s_add_u32 s35, s35, 1
    v_mov_b32 v20, s35
    ds_write_b32 v5, v20
    s_setprio 0
    s_waitcnt lgkmcnt(14)
    v_mfma_f32_32x32x16_bf16 v[32:47], v[160:163], v[164:167], v[32:47]
    ds_read_b32 v21, v6
    s_add_u32 s36, s34, s50
    s_add_u32 s36, s36, 6
    s_and_b32 s36, s36, 7
    s_mul_i32 s36, s36, 196608
    s_add_u32 s36, s36, s7
    s_add_u32 s38, s20, s36
    s_addc_u32 s39, s21, 0
    s_waitcnt lgkmcnt(0)
    v_mfma_f32_32x32x16_bf16 v[48:63], v[160:163], v[168:171], v[48:63]
    s_waitcnt lgkmcnt(0)
    s_setprio 3
    v_cmp_gt_u32 vcc, s35, v21
    s_cbranch_vccz L_ok_82
    s_mov_b32 s46, 0
L_sb_83:
    ds_read_b32 v21, v6 offset:0
    s_waitcnt lgkmcnt(0)
    v_cmp_gt_u32 vcc, s35, v21
    s_add_u32 s46, s46, 1
    s_cmp_eq_u64 vcc, 0
    s_cbranch_scc1 L_sbd_84
    s_sleep 1
    s_cmp_lt_u32 s46, 1600000
    s_cbranch_scc1 L_sb_83
L_sbd_84:
L_ok_82:
    s_setprio 0
    ds_read_b128 v[96:99], v244 offset:0
    ds_read_b64_tr_b16 v[100:101], v248 offset:0
    s_waitcnt lgkmcnt(3)
    v_mfma_f32_32x32x16_bf16 v[32:47], v[172:175], v[176:179], v[32:47]
    ds_read_b64_tr_b16 v[102:103], v248 offset:256
    ds_read_b128 v[104:107], v245 offset:0
    ds_read_b64_tr_b16 v[108:109], v248 offset:2048
    ds_read_b64_tr_b16 v[110:111], v248 offset:2304
    s_add_u32 m0, s5, 114688
    s_waitcnt vmcnt(4)
    global_load_lds_dwordx4 v240, s[38:39]
    s_waitcnt lgkmcnt(3)
    v_mfma_f32_32x32x16_bf16 v[48:63], v[172:175], v[180:183], v[48:63]
    ds_read_b128 v[112:115], v246 offset:0
    ds_read_b64_tr_b16 v[116:117], v248 offset:4096
    ds_read_b64_tr_b16 v[118:119], v248 offset:4352
    ds_read_b128 v[120:123], v247 offset:0
    ds_read_b64_tr_b16 v[124:125], v248 offset:6144
    ds_read_b64_tr_b16 v[126:127], v248 offset:6400
    s_waitcnt lgkmcnt(3)
    v_mfma_f32_32x32x16_bf16 v[32:47], v[184:187], v[188:191], v[32:47]
    s_add_u32 m0, s5, 115712
    s_waitcnt vmcnt(4)
    global_load_lds_dwordx4 v241, s[38:39]
    ds_read_b128 v[128:131], v244 offset:8192
    ds_read_b64_tr_b16 v[132:133], v248 offset:8192
    ds_read_b64_tr_b16 v[134:135], v248 offset:8448
    ds_read_b128 v[136:139], v245 offset:8192
    s_waitcnt lgkmcnt(3)
    v_mfma_f32_32x32x16_bf16 v[48:63], v[184:187], v[192:195], v[48:63]
    ds_read_b64_tr_b16 v[140:141], v248 offset:10240
    ds_read_b64_tr_b16 v[142:143], v248 offset:10496
    s_add_u32 m0, s5, 116736
    s_waitcnt vmcnt(4)
    global_load_lds_dwordx4 v242, s[38:39]
    ds_read_b128 v[144:147], v246 offset:8192
    s_waitcnt lgkmcnt(3)
    v_mfma_f32_32x32x16_bf16 v[32:47], v[196:199], v[200:203], v[32:47]
    ds_read_b64_tr_b16 v[148:149], v248 offset:12288
    ds_read_b64_tr_b16 v[150:151], v248 offset:12544
    ds_read_b128 v[152:155], v247 offset:8192
    ds_read_b64_tr_b16 v[156:157], v248 offset:14336
    ds_read_b64_tr_b16 v[158:159], v248 offset:14592
    s_waitcnt lgkmcnt(3)
    v_mfma_f32_32x32x16_bf16 v[48:63], v[196:199], v[204:207], v[48:63]
    s_add_u32 m0, s5, 117760
    s_waitcnt vmcnt(4)
    global_load_lds_dwordx4 v243, s[38:39]
    s_waitcnt vmcnt(8)
    s_setprio 3
    s_add_u32 s35, s35, 1
    v_mov_b32 v20, s35
    ds_write_b32 v5, v20
    s_setprio 0
    s_sub_u32 s36, s26, 2097152
    s_subb_u32 s37, s27, 0
    global_store_dwordx4 v13, v[252:255], s[36:37] sc1
    global_store_dwordx4 v13, v[252:255], s[36:37] offset:1024 sc1
    s_lshl_b32 s36, s30, 1
    s_add_u32 s36, s36, s51
    s_lshl_b32 s36, s36, 12
    s_add_u32 s36, s36, 65536
    s_add_u32 s40, s26, s36
    s_addc_u32 s41, s27, 0
    s_nop 3
    s_setprio 3
    s_mov_b32 s36, 0x3fb8aa3b
    s_mov_b32 s38, 0x358637bd
    v_pk_fma_f32 v[80:81], v[32:33], s[36:37], v[18:19] op_sel_hi:[1,0,0]
    v_pk_fma_f32 v[82:83], v[34:35], s[36:37], v[18:19] op_sel_hi:[1,0,0]
    v_pk_fma_f32 v[84:85], v[36:37], s[36:37], v[18:19] op_sel_hi:[1,0,0]
    v_pk_fma_f32 v[86:87], v[38:39], s[36:37], v[18:19] op_sel_hi:[1,0,0]
    v_pk_fma_f32 v[88:89], v[40:41], s[36:37], v[18:19] op_sel_hi:[1,0,0]
    v_pk_fma_f32 v[90:91], v[42:43], s[36:37], v[18:19] op_sel_hi:[1,0,0]
    v_pk_fma_f32 v[92:93], v[44:45], s[36:37], v[18:19] op_sel_hi:[1,0,0]
    v_pk_fma_f32 v[94:95], v[46:47], s[36:37], v[18:19] op_sel_hi:[1,0,0]
    v_exp_f32 v80, v80 clamp
    v_exp_f32 v81, v81 clamp
    v_exp_f32 v82, v82 clamp
    v_exp_f32 v83, v83 clamp
    v_exp_f32 v84, v84 clamp
    v_exp_f32 v85, v85 clamp
    v_exp_f32 v86, v86 clamp
    v_exp_f32 v87, v87 clamp
    v_exp_f32 v88, v88 clamp
    v_exp_f32 v89, v89 clamp
    v_exp_f32 v90, v90 clamp
    v_exp_f32 v91, v91 clamp
    v_exp_f32 v92, v92 clamp
    v_exp_f32 v93, v93 clamp
    v_exp_f32 v94, v94 clamp
    v_exp_f32 v95, v95 clamp
    v_max_f32 v32, s38, v32
    v_max_f32 v33, s38, v33
    v_max_f32 v34, s38, v34
    v_max_f32 v35, s38, v35
    v_max_f32 v36, s38, v36
    v_max_f32 v37, s38, v37
    v_max_f32 v38, s38, v38
    v_max_f32 v39, s38, v39
    v_max_f32 v40, s38, v40
    v_max_f32 v41, s38, v41
    v_max_f32 v42, s38, v42
    v_max_f32 v43, s38, v43
    v_max_f32 v44, s38, v44
    v_max_f32 v45, s38, v45
    v_max_f32 v46, s38, v46
    v_max_f32 v47, s38, v47
    v_pk_add_f32 v[32:33], v[32:33], v[80:81]
    v_pk_add_f32 v[34:35], v[34:35], v[82:83]
    v_pk_add_f32 v[36:37], v[36:37], v[84:85]
    v_pk_add_f32 v[38:39], v[38:39], v[86:87]
    v_pk_add_f32 v[40:41], v[40:41], v[88:89]
    v_pk_add_f32 v[42:43], v[42:43], v[90:91]
    v_pk_add_f32 v[44:45], v[44:45], v[92:93]
    v_pk_add_f32 v[46:47], v[46:47], v[94:95]
    v_cvt_pk_bf16_f32 v32, v32, v33
    v_cvt_pk_bf16_f32 v33, v34, v35
    v_cvt_pk_bf16_f32 v34, v36, v37
    v_cvt_pk_bf16_f32 v35, v38, v39
    v_cvt_pk_bf16_f32 v36, v40, v41
    v_cvt_pk_bf16_f32 v37, v42, v43
    v_cvt_pk_bf16_f32 v38, v44, v45
    v_cvt_pk_bf16_f32 v39, v46, v47
    v_cvt_pk_bf16_f32 v48, v48, v49
    v_cvt_pk_bf16_f32 v49, v50, v51
    v_cvt_pk_bf16_f32 v50, v52, v53
    v_cvt_pk_bf16_f32 v51, v54, v55
    v_cvt_pk_bf16_f32 v52, v56, v57
    v_cvt_pk_bf16_f32 v53, v58, v59
    v_cvt_pk_bf16_f32 v54, v60, v61
    v_cvt_pk_bf16_f32 v55, v62, v63
    s_setprio 0
    s_nop 0
    v_mfma_f32_32x32x16_bf16 v[160:175], v[48:51], v[32:35], 0
    v_mfma_f32_32x32x16_bf16 v[160:175], v[52:55], v[36:39], v[160:175]
    v_mfma_f32_32x32x16_bf16 v[176:191], v[224:227], v[32:35], 0
    v_mfma_f32_32x32x16_bf16 v[176:191], v[224:227], v[36:39], v[176:191]
    s_nop 4
    s_setprio 3
    s_mov_b32 exec_lo, 0xffff
    s_mov_b32 exec_hi, 0xffff
    s_cmp_eq_u32 s50, 0
    s_cbranch_scc0 L_k1_85
    ds_write_b128 v11, v[164:167]
    s_not_b64 exec, exec
    ds_write_b128 v11, v[172:175]
    s_branch L_kj_86
L_k1_85:
    ds_write_b128 v11, v[160:163]
    s_not_b64 exec, exec
    ds_write_b128 v11, v[168:171]
L_kj_86:
    s_mov_b64 exec, -1
    s_add_u32 s35, s35, 1
    v_mov_b32 v20, s35
    ds_write_b32 v5, v20
    s_mov_b32 s46, 0
L_sb_89:
    ds_read_b32 v20, v6 offset:0
    s_waitcnt lgkmcnt(0)
    v_cmp_gt_u32 vcc, s35, v20
    s_add_u32 s46, s46, 1
    s_cmp_eq_u64 vcc, 0
    s_cbranch_scc1 L_sbd_90
    s_sleep 1
    s_cmp_lt_u32 s46, 1600000
    s_cbranch_scc1 L_sb_89
L_sbd_90:
    ds_read_b128 v[32:35], v228
    s_mov_b32 exec_lo, 0xffff
    s_mov_b32 exec_hi, 0xffff
    s_cmp_eq_u32 s50, 0
    s_waitcnt lgkmcnt(0)
    s_cbranch_scc0 L_k2_87
    v_pk_add_f32 v[32:33], v[32:33], v[160:161]
    v_pk_add_f32 v[34:35], v[34:35], v[162:163]
    s_not_b64 exec, exec
    v_pk_add_f32 v[32:33], v[32:33], v[168:169]
    v_pk_add_f32 v[34:35], v[34:35], v[170:171]
    s_branch L_kj2_88
L_k2_87:
    v_pk_add_f32 v[32:33], v[32:33], v[164:165]
    v_pk_add_f32 v[34:35], v[34:35], v[166:167]
    s_not_b64 exec, exec
    v_pk_add_f32 v[32:33], v[32:33], v[172:173]
    v_pk_add_f32 v[34:35], v[34:35], v[174:175]
L_kj2_88:
    s_mov_b64 exec, -1
    global_atomic_add_f32 v230, v32, s[40:41] offset:0 sc1
    global_atomic_add_f32 v230, v33, s[40:41] offset:64 sc1
    global_atomic_add_f32 v230, v34, s[40:41] offset:128 sc1
    global_atomic_add_f32 v230, v35, s[40:41] offset:192 sc1
    s_mov_b32 exec_hi, 0
    global_atomic_add_f32 v229, v176, s[40:41] offset:1024 sc1
    s_mov_b32 exec_hi, -1
    s_setprio 0
    s_waitcnt lgkmcnt(14)
    v_mfma_f32_32x32x16_bf16 v[64:79], v[100:103], v[96:99], v[64:79]
    ds_read_b32 v21, v6
    s_waitcnt lgkmcnt(0)
    v_mfma_f32_32x32x16_bf16 v[64:79], v[108:111], v[104:107], v[64:79]
    s_waitcnt lgkmcnt(0)
    s_setprio 3
    v_cmp_gt_u32 vcc, s35, v21
    s_cbranch_vccz L_ok_91
    s_mov_b32 s46, 0
L_sb_92:
    ds_read_b32 v21, v6 offset:0
    s_waitcnt lgkmcnt(0)
    v_cmp_gt_u32 vcc, s35, v21
    s_add_u32 s46, s46, 1
    s_cmp_eq_u64 vcc, 0
    s_cbranch_scc1 L_sbd_93
    s_sleep 1
    s_cmp_lt_u32 s46, 1600000
    s_cbranch_scc1 L_sb_92
L_sbd_93:
L_ok_91:
    s_setprio 0
    ds_read_b128 v[160:163], v244 offset:16384
    s_waitcnt lgkmcnt(3)
    v_mfma_f32_32x32x16_bf16 v[64:79], v[116:119], v[112:115], v[64:79]
    ds_read_b64_tr_b16 v[164:165], v248 offset:16384
    ds_read_b64_tr_b16 v[166:167], v248 offset:16640
    ds_read_b128 v[168:171], v245 offset:16384
    ds_read_b64_tr_b16 v[172:173], v248 offset:18432
    ds_read_b64_tr_b16 v[174:175], v248 offset:18688
    s_waitcnt lgkmcnt(3)
    v_mfma_f32_32x32x16_bf16 v[64:79], v[124:127], v[120:123], v[64:79]
    ds_read_b128 v[176:179], v246 offset:16384
    ds_read_b64_tr_b16 v[180:181], v248 offset:20480
    ds_read_b64_tr_b16 v[182:183], v248 offset:20736
    ds_read_b128 v[184:187], v247 offset:16384
    ds_read_b64_tr_b16 v[188:189], v248 offset:22528
    s_waitcnt lgkmcnt(3)
    v_mfma_f32_32x32x16_bf16 v[64:79], v[132:135], v[128:131], v[64:79]
    ds_read_b64_tr_b16 v[190:191], v248 offset:22784
    ds_read_b128 v[192:195], v244 offset:24576
    ds_read_b64_tr_b16 v[196:197], v248 offset:24576
    ds_read_b64_tr_b16 v[198:199], v248 offset:24832
    s_waitcnt lgkmcnt(3)
    v_mfma_f32_32x32x16_bf16 v[64:79], v[140:143], v[136:139], v[64:79]
    ds_read_b128 v[200:203], v245 offset:24576
    ds_read_b64_tr_b16 v[204:205], v248 offset:26624
    ds_read_b64_tr_b16 v[206:207], v248 offset:26880
    ds_read_b128 v[208:211], v246 offset:24576
    ds_read_b64_tr_b16 v[212:213], v248 offset:28672
    s_waitcnt lgkmcnt(3)
    v_mfma_f32_32x32x16_bf16 v[64:79], v[148:151], v[144:147], v[64:79]
    ds_read_b64_tr_b16 v[214:215], v248 offset:28928
    ds_read_b128 v[216:219], v247 offset:24576
    ds_read_b64_tr_b16 v[220:221], v248 offset:30720
    ds_read_b64_tr_b16 v[222:223], v248 offset:30976
    s_waitcnt lgkmcnt(3)
    v_mfma_f32_32x32x16_bf16 v[64:79], v[156:159], v[152:155], v[64:79]
    s_waitcnt vmcnt(0)
    s_mov_b32 s35, 29
    s_setprio 3
    s_add_u32 s35, s35, 1
    v_mov_b32 v20, s35
    ds_write_b32 v5, v20
    s_setprio 0
    s_waitcnt lgkmcnt(14)
    v_mfma_f32_32x32x16_bf16 v[64:79], v[164:167], v[160:163], v[64:79]
    ds_read_b32 v21, v6
    s_add_u32 s36, s29, 0
    s_and_b32 s36, s36, 3
    s_lshl_b32 s36, s36, 2
    s_add_u32 s36, s36, s52
    s_lshl_b32 s36, s36, 8
    s_add_u32 s36, s36, s30
    s_lshl_b32 s36, s36, 7
    s_add_u32 s38, s16, s36
    s_addc_u32 s39, s17, 0
    s_waitcnt lgkmcnt(0)
    v_mfma_f32_32x32x16_bf16 v[64:79], v[172:175], v[168:171], v[64:79]
    s_waitcnt lgkmcnt(0)
    s_setprio 3
    v_cmp_gt_u32 vcc, s35, v21
    s_cbranch_vccz L_ok_94
    s_mov_b32 s46, 0
L_sb_95:
    ds_read_b32 v21, v6 offset:0
    s_waitcnt lgkmcnt(0)
    v_cmp_gt_u32 vcc, s35, v21
    s_add_u32 s46, s46, 1
    s_cmp_eq_u64 vcc, 0
    s_cbranch_scc1 L_sbd_96
    s_sleep 1
    s_cmp_lt_u32 s46, 1600000
    s_cbranch_scc1 L_sb_95
L_sbd_96:
L_ok_94:
    s_setprio 0
    s_cmp_lg_u32 s52, 0
    s_cbranch_scc1 L_b_97
    s_lshl_b32 s42, s29, 7
    s_add_u32 s42, s8, s42
    s_addc_u32 s43, s9, 0
    s_mov_b64 exec, 1
    global_store_dword v1, v7, s[42:43] sc1
    s_mov_b64 exec, -1
L_b_97:
    ds_read_b128 v[96:99], v244 offset:32768
    ds_read_b64_tr_b16 v[100:101], v248 offset:32768
    s_waitcnt lgkmcnt(3)
    v_mfma_f32_32x32x16_bf16 v[64:79], v[180:183], v[176:179], v[64:79]
    ds_read_b64_tr_b16 v[102:103], v248 offset:33024
    ds_read_b128 v[104:107], v245 offset:32768
    ds_read_b64_tr_b16 v[108:109], v248 offset:34816
    ds_read_b64_tr_b16 v[110:111], v248 offset:35072
    s_add_u32 m0, s5, 0
    s_waitcnt vmcnt(3)
    global_load_lds_dwordx4 v28, s[38:39]
    s_waitcnt lgkmcnt(3)
    v_mfma_f32_32x32x16_bf16 v[64:79], v[188:191], v[184:187], v[64:79]
    ds_read_b128 v[112:115], v246 offset:32768
    ds_read_b64_tr_b16 v[116:117], v248 offset:36864
    ds_read_b64_tr_b16 v[118:119], v248 offset:37120
    ds_read_b128 v[120:123], v247 offset:32768
    ds_read_b64_tr_b16 v[124:125], v248 offset:38912
    ds_read_b64_tr_b16 v[126:127], v248 offset:39168
    s_waitcnt lgkmcnt(3)
    v_mfma_f32_32x32x16_bf16 v[64:79], v[196:199], v[192:195], v[64:79]
    s_add_u32 m0, s5, 1024
    s_waitcnt vmcnt(3)
    global_load_lds_dwordx4 v29, s[38:39]
    ds_read_b128 v[128:131], v244 offset:40960
    ds_read_b64_tr_b16 v[132:133], v248 offset:40960
    ds_read_b64_tr_b16 v[134:135], v248 offset:41216
    ds_read_b128 v[136:139], v245 offset:40960
    s_waitcnt lgkmcnt(3)
    v_mfma_f32_32x32x16_bf16 v[64:79], v[204:207], v[200:203], v[64:79]
    ds_read_b64_tr_b16 v[140:141], v248 offset:43008
    ds_read_b64_tr_b16 v[142:143], v248 offset:43264
    s_add_u32 m0, s5, 2048
    s_waitcnt vmcnt(3)
    global_load_lds_dwordx4 v30, s[38:39]
    ds_read_b128 v[144:147], v246 offset:40960
    s_waitcnt lgkmcnt(3)
    v_mfma_f32_32x32x16_bf16 v[64:79], v[212:215], v[208:211], v[64:79]
    ds_read_b64_tr_b16 v[148:149], v248 offset:45056
    ds_read_b64_tr_b16 v[150:151], v248 offset:45312
    ds_read_b128 v[152:155], v247 offset:40960
    ds_read_b64_tr_b16 v[156:157], v248 offset:47104
    ds_read_b64_tr_b16 v[158:159], v248 offset:47360
    s_waitcnt lgkmcnt(3)
    v_mfma_f32_32x32x16_bf16 v[64:79], v[220:223], v[216:219], v[64:79]
    s_add_u32 m0, s5, 3072
    s_waitcnt vmcnt(3)
    global_load_lds_dwordx4 v31, s[38:39]
    s_setprio 3
    s_add_u32 s35, s35, 1
    v_mov_b32 v20, s35
    ds_write_b32 v5, v20
    s_setprio 0
    s_waitcnt lgkmcnt(14)
    v_mfma_f32_32x32x16_bf16 v[64:79], v[100:103], v[96:99], v[64:79]
    ds_read_b32 v21, v6
    s_add_u32 s36, s29, 1
    s_and_b32 s36, s36, 3
    s_lshl_b32 s36, s36, 2
    s_add_u32 s36, s36, s52
    s_lshl_b32 s36, s36, 8
    s_add_u32 s36, s36, s30
    s_lshl_b32 s36, s36, 7
    s_add_u32 s38, s16, s36
    s_addc_u32 s39, s17, 0
    s_waitcnt lgkmcnt(0)
    v_mfma_f32_32x32x16_bf16 v[64:79], v[108:111], v[104:107], v[64:79]
    s_waitcnt lgkmcnt(0)
    s_setprio 3
    v_cmp_gt_u32 vcc, s35, v21
    s_cbranch_vccz L_ok_98
    s_mov_b32 s46, 0
L_sb_99:
    ds_read_b32 v21, v6 offset:0
    s_waitcnt lgkmcnt(0)
    v_cmp_gt_u32 vcc, s35, v21
    s_add_u32 s46, s46, 1
    s_cmp_eq_u64 vcc, 0
    s_cbranch_scc1 L_sbd_100
    s_sleep 1
    s_cmp_lt_u32 s46, 1600000
    s_cbranch_scc1 L_sb_99
L_sbd_100:
L_ok_98:
    s_setprio 0
    ds_read_b128 v[160:163], v244 offset:49152
    ds_read_b64_tr_b16 v[164:165], v248 offset:49152
    s_waitcnt lgkmcnt(3)
    v_mfma_f32_32x32x16_bf16 v[64:79], v[116:119], v[112:115], v[64:79]
    ds_read_b64_tr_b16 v[166:167], v248 offset:49408
    ds_read_b128 v[168:171], v245 offset:49152
    ds_read_b64_tr_b16 v[172:173], v248 offset:51200
    ds_read_b64_tr_b16 v[174:175], v248 offset:51456
    s_add_u32 m0, s5, 16384
    s_waitcnt vmcnt(3)
    global_load_lds_dwordx4 v28, s[38:39]
    s_waitcnt lgkmcnt(3)
    v_mfma_f32_32x32x16_bf16 v[64:79], v[124:127], v[120:123], v[64:79]
    ds_read_b128 v[176:179], v246 offset:49152
    ds_read_b64_tr_b16 v[180:181], v248 offset:53248
    ds_read_b64_tr_b16 v[182:183], v248 offset:53504
    ds_read_b128 v[184:187], v247 offset:49152
    ds_read_b64_tr_b16 v[188:189], v248 offset:55296
    ds_read_b64_tr_b16 v[190:191], v248 offset:55552
    s_waitcnt lgkmcnt(3)
    v_mfma_f32_32x32x16_bf16 v[64:79], v[132:135], v[128:131], v[64:79]
    s_add_u32 m0, s5, 17408
    s_waitcnt vmcnt(3)
    global_load_lds_dwordx4 v29, s[38:39]
    ds_read_b128 v[192:195], v244 offset:57344
    ds_read_b64_tr_b16 v[196:197], v248 offset:57344
    ds_read_b64_tr_b16 v[198:199], v248 offset:57600
    ds_read_b128 v[200:203], v245 offset:57344
    s_waitcnt lgkmcnt(3)
    v_mfma_f32_32x32x16_bf16 v[64:79], v[140:143], v[136:139], v[64:79]
    ds_read_b64_tr_b16 v[204:205], v248 offset:59392
    ds_read_b64_tr_b16 v[206:207], v248 offset:59648
    s_add_u32 m0, s5, 18432
    s_waitcnt vmcnt(3)
    global_load_lds_dwordx4 v30, s[38:39]
    ds_read_b128 v[208:211], v246 offset:57344
    s_waitcnt lgkmcnt(3)
    v_mfma_f32_32x32x16_bf16 v[64:79], v[148:151], v[144:147], v[64:79]
    ds_read_b64_tr_b16 v[212:213], v248 offset:61440
    ds_read_b64_tr_b16 v[214:215], v248 offset:61696
    ds_read_b128 v[216:219], v247 offset:57344
    ds_read_b64_tr_b16 v[220:221], v248 offset:63488
    ds_read_b64_tr_b16 v[222:223], v248 offset:63744
    s_waitcnt lgkmcnt(3)
    v_mfma_f32_32x32x16_bf16 v[64:79], v[156:159], v[152:155], v[64:79]
    s_add_u32 m0, s5, 19456
    s_waitcnt vmcnt(3)
    global_load_lds_dwordx4 v31, s[38:39]
    s_setprio 3
    s_add_u32 s35, s35, 1
    v_mov_b32 v20, s35
    ds_write_b32 v5, v20
    s_setprio 0
    s_waitcnt lgkmcnt(14)
    v_mfma_f32_32x32x16_bf16 v[64:79], v[164:167], v[160:163], v[64:79]
    ds_read_b32 v21, v6
    s_add_u32 s36, s29, 2
    s_and_b32 s36, s36, 3
    s_lshl_b32 s36, s36, 2
    s_add_u32 s36, s36, s52
    s_lshl_b32 s36, s36, 8
    s_add_u32 s36, s36, s30
    s_lshl_b32 s36, s36, 7
    s_add_u32 s38, s16, s36
    s_addc_u32 s39, s17, 0
    s_waitcnt lgkmcnt(0)
    v_mfma_f32_32x32x16_bf16 v[64:79], v[172:175], v[168:171], v[64:79]
    s_waitcnt lgkmcnt(0)
    s_setprio 3
    v_cmp_gt_u32 vcc, s35, v21
    s_cbranch_vccz L_ok_101
    s_mov_b32 s46, 0
L_sb_102:
    ds_read_b32 v21, v6 offset:0
    s_waitcnt lgkmcnt(0)
    v_cmp_gt_u32 vcc, s35, v21
    s_add_u32 s46, s46, 1
    s_cmp_eq_u64 vcc, 0
    s_cbranch_scc1 L_sbd_103
    s_sleep 1
    s_cmp_lt_u32 s46, 1600000
    s_cbranch_scc1 L_sb_102
L_sbd_103:
L_ok_101:
    s_setprio 0
    v_mfma_f32_32x32x16_bf16 v[64:79], v[180:183], v[176:179], v[64:79]
    s_add_u32 m0, s5, 32768
    s_waitcnt vmcnt(3)
    global_load_lds_dwordx4 v28, s[38:39]
    v_mfma_f32_32x32x16_bf16 v[64:79], v[188:191], v[184:187], v[64:79]
    s_add_u32 m0, s5, 33792
    s_waitcnt vmcnt(3)
    global_load_lds_dwordx4 v29, s[38:39]
    v_mfma_f32_32x32x16_bf16 v[64:79], v[196:199], v[192:195], v[64:79]
    s_add_u32 m0, s5, 34816
    s_waitcnt vmcnt(3)
    global_load_lds_dwordx4 v30, s[38:39]
    v_mfma_f32_32x32x16_bf16 v[64:79], v[204:207], v[200:203], v[64:79]
    s_add_u32 m0, s5, 35840
    s_waitcnt vmcnt(3)
    global_load_lds_dwordx4 v31, s[38:39]
    v_mfma_f32_32x32x16_bf16 v[64:79], v[212:215], v[208:211], v[64:79]
    v_mfma_f32_32x32x16_bf16 v[64:79], v[220:223], v[216:219], v[64:79]
    s_nop 8
    s_add_u32 s36, s29, 3
    s_and_b32 s36, s36, 3
    s_lshl_b32 s36, s36, 2
    s_add_u32 s36, s36, s52
    s_lshl_b32 s36, s36, 8
    s_add_u32 s36, s36, s30
    s_lshl_b32 s36, s36, 7
    s_add_u32 s38, s16, s36
    s_addc_u32 s39, s17, 0
    s_add_u32 m0, s5, 49152
    s_waitcnt vmcnt(3)
    global_load_lds_dwordx4 v28, s[38:39]
    s_add_u32 m0, s5, 50176
    s_waitcnt vmcnt(3)
    global_load_lds_dwordx4 v29, s[38:39]
    s_add_u32 m0, s5, 51200
    s_waitcnt vmcnt(3)
    global_load_lds_dwordx4 v30, s[38:39]
    s_add_u32 m0, s5, 52224
    s_waitcnt vmcnt(3)
    global_load_lds_dwordx4 v31, s[38:39]
    s_setprio 3
    s_mov_b32 s36, 0x3fb8aa3b
    s_mov_b32 s38, 0x358637bd
    v_pk_fma_f32 v[80:81], v[64:65], s[36:37], v[18:19] op_sel_hi:[1,0,0]
    v_pk_fma_f32 v[82:83], v[66:67], s[36:37], v[18:19] op_sel_hi:[1,0,0]
    v_pk_fma_f32 v[84:85], v[68:69], s[36:37], v[18:19] op_sel_hi:[1,0,0]
    v_pk_fma_f32 v[86:87], v[70:71], s[36:37], v[18:19] op_sel_hi:[1,0,0]
    v_pk_fma_f32 v[88:89], v[72:73], s[36:37], v[18:19] op_sel_hi:[1,0,0]
    v_pk_fma_f32 v[90:91], v[74:75], s[36:37], v[18:19] op_sel_hi:[1,0,0]
    v_pk_fma_f32 v[92:93], v[76:77], s[36:37], v[18:19] op_sel_hi:[1,0,0]
    v_pk_fma_f32 v[94:95], v[78:79], s[36:37], v[18:19] op_sel_hi:[1,0,0]
    v_exp_f32 v80, v80 clamp
    v_exp_f32 v81, v81 clamp
    v_exp_f32 v82, v82 clamp
    v_exp_f32 v83, v83 clamp
    v_exp_f32 v84, v84 clamp
    v_exp_f32 v85, v85 clamp
    v_exp_f32 v86, v86 clamp
    v_exp_f32 v87, v87 clamp
    v_exp_f32 v88, v88 clamp
    v_exp_f32 v89, v89 clamp
    v_exp_f32 v90, v90 clamp
    v_exp_f32 v91, v91 clamp
    v_exp_f32 v92, v92 clamp
    v_exp_f32 v93, v93 clamp
    v_exp_f32 v94, v94 clamp
    v_exp_f32 v95, v95 clamp
    v_max_f32 v64, s38, v64
    v_max_f32 v65, s38, v65
    v_max_f32 v66, s38, v66
    v_max_f32 v67, s38, v67
    v_max_f32 v68, s38, v68
    v_max_f32 v69, s38, v69
    v_max_f32 v70, s38, v70
    v_max_f32 v71, s38, v71
    v_max_f32 v72, s38, v72
    v_max_f32 v73, s38, v73
    v_max_f32 v74, s38, v74
    v_max_f32 v75, s38, v75
    v_max_f32 v76, s38, v76
    v_max_f32 v77, s38, v77
    v_max_f32 v78, s38, v78
    v_max_f32 v79, s38, v79
    v_pk_add_f32 v[64:65], v[64:65], v[80:81]
    v_pk_add_f32 v[66:67], v[66:67], v[82:83]
    v_pk_add_f32 v[68:69], v[68:69], v[84:85]
    v_pk_add_f32 v[70:71], v[70:71], v[86:87]
    v_pk_add_f32 v[72:73], v[72:73], v[88:89]
    v_pk_add_f32 v[74:75], v[74:75], v[90:91]
    v_pk_add_f32 v[76:77], v[76:77], v[92:93]
    v_pk_add_f32 v[78:79], v[78:79], v[94:95]
    v_cvt_pk_bf16_f32 v64, v64, v65
    v_cvt_pk_bf16_f32 v65, v66, v67
    v_cvt_pk_bf16_f32 v66, v68, v69
    v_cvt_pk_bf16_f32 v67, v70, v71
    v_cvt_pk_bf16_f32 v68, v72, v73
    v_cvt_pk_bf16_f32 v69, v74, v75
    v_cvt_pk_bf16_f32 v70, v76, v77
    v_cvt_pk_bf16_f32 v71, v78, v79
    s_setprio 0
    s_lshl_b32 s36, s30, 1
    s_add_u32 s36, s36, s51
    s_lshl_b32 s36, s36, 12
    s_add_u32 s36, s36, 65536
    s_add_u32 s40, s26, s36
    s_addc_u32 s41, s27, 0
    s_setprio 3
    s_cmp_lg_u32 s52, 1
    s_cbranch_scc1 L_nr_104
    s_mov_b32 exec_hi, 0
    s_mov_b32 s46, 0
L_poll_105:
    global_load_dword v21, v10, s[8:9] offset:0 sc1
    s_waitcnt vmcnt(0)
    v_cmp_ne_u32 vcc, s32, v21
    s_add_u32 s46, s46, 1
    s_cmp_eq_u64 vcc, 0
    s_cbranch_scc1 L_polld_106
    s_sleep 8
    s_cmp_lt_u32 s46, 200000
    s_cbranch_scc1 L_poll_105
L_polld_106:
    s_mov_b32 exec_hi, -1
L_nr_104:
    s_waitcnt vmcnt(0)
    s_add_u32 s35, s35, 1
    v_mov_b32 v20, s35
    ds_write_b32 v5, v20
    s_mov_b32 s46, 0
L_sb_107:
    ds_read_b32 v20, v6 offset:0
    s_waitcnt lgkmcnt(0)
    v_cmp_gt_u32 vcc, s35, v20
    s_add_u32 s46, s46, 1
    s_cmp_eq_u64 vcc, 0
    s_cbranch_scc1 L_sbd_108
    s_sleep 2
    s_cmp_lt_u32 s46, 1600000
    s_cbranch_scc1 L_sb_107
L_sbd_108:
    global_load_dwordx4 v[96:99], v12, s[40:41] offset:0 sc1
    global_load_dwordx4 v[100:103], v12, s[40:41] offset:32 sc1
    global_load_dwordx4 v[104:107], v12, s[40:41] offset:2048 sc1
    global_load_dwordx4 v[108:111], v12, s[40:41] offset:2080 sc1
    s_add_u32 s36, s30, 0
    s_and_b32 s36, s36, 3
    s_lshl_b32 s37, s51, 2
    s_add_u32 s36, s36, s37
    s_lshl_b32 s37, s29, 1
    s_sub_u32 s36, s36, s37
    s_and_b32 s36, s36, 7
    s_lshl_b32 s36, s36, 13
    v_add_u32 v21, s36, v8
    ds_read_b64_tr_b16 v[128:129], v21 offset:0
    ds_read_b64_tr_b16 v[130:131], v21 offset:1024
    ds_read_b64_tr_b16 v[132:133], v21 offset:512
    ds_read_b64_tr_b16 v[134:135], v21 offset:1536
    ds_read_b64_tr_b16 v[136:137], v21 offset:2048
    ds_read_b64_tr_b16 v[138:139], v21 offset:3072
    ds_read_b64_tr_b16 v[140:141], v21 offset:2560
    ds_read_b64_tr_b16 v[142:143], v21 offset:3584
    ds_read_b64_tr_b16 v[144:145], v21 offset:4096
    ds_read_b64_tr_b16 v[146:147], v21 offset:5120
    ds_read_b64_tr_b16 v[148:149], v21 offset:4608
    ds_read_b64_tr_b16 v[150:151], v21 offset:5632
    ds_read_b64_tr_b16 v[152:153], v21 offset:6144
    ds_read_b64_tr_b16 v[154:155], v21 offset:7168
    ds_read_b64_tr_b16 v[156:157], v21 offset:6656
    ds_read_b64_tr_b16 v[158:159], v21 offset:7680
    s_add_u32 s36, s30, 1
    s_and_b32 s36, s36, 3
    s_lshl_b32 s37, s51, 2
    s_add_u32 s36, s36, s37
    s_lshl_b32 s37, s29, 1
    s_sub_u32 s36, s36, s37
    s_and_b32 s36, s36, 7
    s_lshl_b32 s36, s36, 13
    v_add_u32 v21, s36, v8
    ds_read_b64_tr_b16 v[160:161], v21 offset:0
    ds_read_b64_tr_b16 v[162:163], v21 offset:1024
    ds_read_b64_tr_b16 v[164:165], v21 offset:512
    ds_read_b64_tr_b16 v[166:167], v21 offset:1536
    ds_read_b64_tr_b16 v[168:169], v21 offset:2048
    ds_read_b64_tr_b16 v[170:171], v21 offset:3072
    ds_read_b64_tr_b16 v[172:173], v21 offset:2560
    ds_read_b64_tr_b16 v[174:175], v21 offset:3584
    ds_read_b64_tr_b16 v[176:177], v21 offset:4096
    ds_read_b64_tr_b16 v[178:179], v21 offset:5120
    ds_read_b64_tr_b16 v[180:181], v21 offset:4608
    ds_read_b64_tr_b16 v[182:183], v21 offset:5632
    ds_read_b64_tr_b16 v[184:185], v21 offset:6144
    ds_read_b64_tr_b16 v[186:187], v21 offset:7168
    ds_read_b64_tr_b16 v[188:189], v21 offset:6656
    ds_read_b64_tr_b16 v[190:191], v21 offset:7680
    s_add_u32 s36, s30, 2
    s_and_b32 s36, s36, 3
    s_lshl_b32 s37, s51, 2
    s_add_u32 s36, s36, s37
    s_lshl_b32 s37, s29, 1
    s_sub_u32 s36, s36, s37
    s_and_b32 s36, s36, 7
    s_lshl_b32 s36, s36, 13
    v_add_u32 v21, s36, v8
    ds_read_b64_tr_b16 v[192:193], v21 offset:0
    ds_read_b64_tr_b16 v[194:195], v21 offset:1024
    ds_read_b64_tr_b16 v[196:197], v21 offset:512
    ds_read_b64_tr_b16 v[198:199], v21 offset:1536
    ds_read_b64_tr_b16 v[200:201], v21 offset:2048
    ds_read_b64_tr_b16 v[202:203], v21 offset:3072
    ds_read_b64_tr_b16 v[204:205], v21 offset:2560
    ds_read_b64_tr_b16 v[206:207], v21 offset:3584
    ds_read_b64_tr_b16 v[208:209], v21 offset:4096
    ds_read_b64_tr_b16 v[210:211], v21 offset:5120
    ds_read_b64_tr_b16 v[212:213], v21 offset:4608
    ds_read_b64_tr_b16 v[214:215], v21 offset:5632
    ds_read_b64_tr_b16 v[216:217], v21 offset:6144
    ds_read_b64_tr_b16 v[218:219], v21 offset:7168
    ds_read_b64_tr_b16 v[220:221], v21 offset:6656
    ds_read_b64_tr_b16 v[222:223], v21 offset:7680
    s_add_u32 s36, s30, 3
    s_and_b32 s36, s36, 3
    s_lshl_b32 s37, s51, 2
    s_add_u32 s36, s36, s37
    s_lshl_b32 s37, s29, 1
    s_sub_u32 s36, s36, s37
    s_and_b32 s36, s36, 7
    s_lshl_b32 s36, s36, 13
    v_add_u32 v21, s36, v8
    ds_read_b64_tr_b16 v[224:225], v21 offset:0
    ds_read_b64_tr_b16 v[226:227], v21 offset:1024
    ds_read_b64_tr_b16 v[228:229], v21 offset:512
    ds_read_b64_tr_b16 v[230:231], v21 offset:1536
    ds_read_b64_tr_b16 v[232:233], v21 offset:2048
    ds_read_b64_tr_b16 v[234:235], v21 offset:3072
    ds_read_b64_tr_b16 v[236:237], v21 offset:2560
    ds_read_b64_tr_b16 v[238:239], v21 offset:3584
    ds_read_b64_tr_b16 v[240:241], v21 offset:4096
    ds_read_b64_tr_b16 v[242:243], v21 offset:5120
    ds_read_b64_tr_b16 v[244:245], v21 offset:4608
    ds_read_b64_tr_b16 v[246:247], v21 offset:5632
    ds_read_b64_tr_b16 v[248:249], v21 offset:6144
    ds_read_b64_tr_b16 v[250:251], v21 offset:7168
    ds_read_b64_tr_b16 v[252:253], v21 offset:6656
    ds_read_b64_tr_b16 v[254:255], v21 offset:7680
    s_add_u32 s35, s35, 1
    v_mov_b32 v20, s35
    ds_write_b32 v5, v20
    s_add_u32 s36, s29, 0
    s_and_b32 s36, s36, 3
    s_lshl_b32 s36, s36, 2
    s_add_u32 s36, s36, s52
    s_lshl_b32 s36, s36, 8
    s_add_u32 s36, s36, s30
    s_lshl_b32 s36, s36, 7
    s_add_u32 s38, s22, s36
    s_addc_u32 s39, s23, 0
    s_add_u32 m0, s5, 65536
    s_waitcnt vmcnt(3)
    global_load_lds_dwordx4 v28, s[38:39]
    s_add_u32 m0, s5, 66560
    s_waitcnt vmcnt(3)
    global_load_lds_dwordx4 v29, s[38:39]
    s_add_u32 m0, s5, 67584
    s_waitcnt vmcnt(3)
    global_load_lds_dwordx4 v30, s[38:39]
    s_add_u32 m0, s5, 68608
    s_waitcnt vmcnt(3)
    global_load_lds_dwordx4 v31, s[38:39]
    s_waitcnt vmcnt(4)
    v_cvt_pk_bf16_f32 v96, v96, v97
    v_cvt_pk_bf16_f32 v97, v98, v99
    v_cvt_pk_bf16_f32 v98, v100, v101
    v_cvt_pk_bf16_f32 v99, v102, v103
    v_cvt_pk_bf16_f32 v100, v104, v105
    v_cvt_pk_bf16_f32 v101, v106, v107
    v_cvt_pk_bf16_f32 v102, v108, v109
    v_cvt_pk_bf16_f32 v103, v110, v111
    s_nop 1
    v_mfma_f32_32x32x16_bf16 v[32:47], v[96:99], v[64:67], 0
    v_mfma_f32_32x32x16_bf16 v[48:63], v[100:103], v[68:71], 0
    s_nop 7
    s_nop 3
    v_add_f32 v40, 0x358637bd, v40
    v_add_f32 v56, 0x358637bd, v56
    v_rcp_f32 v40, v40
    v_rcp_f32 v56, v56
    v_pk_mul_f32 v[32:33], v[32:33], v[40:41] op_sel_hi:[1,0]
    v_pk_mul_f32 v[34:35], v[34:35], v[40:41] op_sel_hi:[1,0]
    v_pk_mul_f32 v[36:37], v[36:37], v[40:41] op_sel_hi:[1,0]
    v_pk_mul_f32 v[38:39], v[38:39], v[40:41] op_sel_hi:[1,0]
    v_cvt_pk_bf16_f32 v80, v32, v33
    v_cvt_pk_bf16_f32 v81, v34, v35
    v_cvt_pk_bf16_f32 v82, v36, v37
    v_cvt_pk_bf16_f32 v83, v38, v39
    global_store_dwordx4 v13, v[80:83], s[26:27] offset:0 sc1
    v_pk_mul_f32 v[48:49], v[48:49], v[56:57] op_sel_hi:[1,0]
    v_pk_mul_f32 v[50:51], v[50:51], v[56:57] op_sel_hi:[1,0]
    v_pk_mul_f32 v[52:53], v[52:53], v[56:57] op_sel_hi:[1,0]
    v_pk_mul_f32 v[54:55], v[54:55], v[56:57] op_sel_hi:[1,0]
    v_cvt_pk_bf16_f32 v84, v48, v49
    v_cvt_pk_bf16_f32 v85, v50, v51
    v_cvt_pk_bf16_f32 v86, v52, v53
    v_cvt_pk_bf16_f32 v87, v54, v55
    global_store_dwordx4 v13, v[84:87], s[26:27] offset:1024 sc1
    s_setprio 0
    s_add_u32 s36, s29, 1
    s_and_b32 s36, s36, 3
    s_lshl_b32 s36, s36, 2
    s_add_u32 s36, s36, s52
    s_lshl_b32 s36, s36, 8
    s_add_u32 s36, s36, s30
    s_lshl_b32 s36, s36, 7
    s_add_u32 s38, s22, s36
    s_addc_u32 s39, s23, 0
    s_add_u32 m0, s5, 81920
    s_waitcnt vmcnt(3)
    global_load_lds_dwordx4 v28, s[38:39]
    s_add_u32 m0, s5, 82944
    s_waitcnt vmcnt(3)
    global_load_lds_dwordx4 v29, s[38:39]
    s_add_u32 m0, s5, 83968
    s_waitcnt vmcnt(3)
    global_load_lds_dwordx4 v30, s[38:39]
    s_add_u32 m0, s5, 84992
    s_waitcnt vmcnt(3)
    global_load_lds_dwordx4 v31, s[38:39]
    s_waitcnt vmcnt(4)
    s_mov_b32 s47, 1
    s_atomic_add s47, s[10:11], 0 glc
    s_add_u32 s36, s29, 2
    s_and_b32 s36, s36, 3
    s_lshl_b32 s36, s36, 2
    s_add_u32 s36, s36, s52
    s_lshl_b32 s36, s36, 8
    s_add_u32 s36, s36, s30
    s_lshl_b32 s36, s36, 7
    s_add_u32 s38, s22, s36
    s_addc_u32 s39, s23, 0
    s_add_u32 m0, s5, 98304
    s_waitcnt vmcnt(3)
    global_load_lds_dwordx4 v28, s[38:39]
    s_add_u32 m0, s5, 99328
    s_waitcnt vmcnt(3)
    global_load_lds_dwordx4 v29, s[38:39]
    s_add_u32 m0, s5, 100352
    s_waitcnt vmcnt(3)
    global_load_lds_dwordx4 v30, s[38:39]
    s_add_u32 m0, s5, 101376
    s_waitcnt vmcnt(3)
    global_load_lds_dwordx4 v31, s[38:39]
    s_add_u32 s36, s29, 3
    s_and_b32 s36, s36, 3
    s_lshl_b32 s36, s36, 2
    s_add_u32 s36, s36, s52
    s_lshl_b32 s36, s36, 8
    s_add_u32 s36, s36, s30
    s_lshl_b32 s36, s36, 7
    s_add_u32 s38, s22, s36
    s_addc_u32 s39, s23, 0
    s_add_u32 m0, s5, 114688
    s_waitcnt vmcnt(3)
    global_load_lds_dwordx4 v28, s[38:39]
    s_add_u32 m0, s5, 115712
    s_waitcnt vmcnt(3)
    global_load_lds_dwordx4 v29, s[38:39]
    s_add_u32 m0, s5, 116736
    s_waitcnt vmcnt(3)
    global_load_lds_dwordx4 v30, s[38:39]
    s_add_u32 m0, s5, 117760
    s_waitcnt vmcnt(3)
    global_load_lds_dwordx4 v31, s[38:39]
    s_load_dword s44, s[12:13], 0 glc
    s_mov_b32 s46, 0
L_cw_109:
    s_waitcnt lgkmcnt(0)
    s_cmp_ge_u32 s44, 8
    s_cbranch_scc1 L_cwd_110
    s_sleep 2
    s_load_dword s44, s[12:13], 0 glc
    s_add_u32 s46, s46, 1
    s_cmp_lt_u32 s46, 200000
    s_cbranch_scc1 L_cw_109
    s_waitcnt lgkmcnt(0)
L_cwd_110:
    s_setprio 3
    s_mov_b32 s46, 0
L_sb_111:
    ds_read_b32 v20, v6 offset:0
    s_waitcnt lgkmcnt(0)
    v_cmp_gt_u32 vcc, s35, v20
    s_add_u32 s46, s46, 1
    s_cmp_eq_u64 vcc, 0
    s_cbranch_scc1 L_sbd_112
    s_sleep 1
    s_cmp_lt_u32 s46, 1600000
    s_cbranch_scc1 L_sb_111
L_sbd_112:
    s_lshl_b32 s5, s50, 15
    s_lshl_b32 s7, s51, 14
    s_lshl_b32 s36, s29, 13
    s_sub_u32 s7, s7, s36
    s_add_u32 s36, s30, 0
    s_and_b32 s36, s36, 3
    s_lshl_b32 s36, s36, 12
    s_add_u32 s37, s36, s7
    s_and_b32 s37, s37, 0x7fff
    s_add_u32 m0, s5, s37
    s_add_u32 s36, s36, 2097152
    s_add_u32 s38, s54, s36
    s_addc_u32 s39, s55, 0
    s_waitcnt vmcnt(3)
    global_load_lds_dwordx4 v4, s[38:39] offset:0 sc1
    s_waitcnt vmcnt(3)
    global_load_lds_dwordx4 v4, s[38:39] offset:1024 sc1
    s_waitcnt vmcnt(3)
    global_load_lds_dwordx4 v4, s[38:39] offset:2048 sc1
    s_waitcnt vmcnt(3)
    global_load_lds_dwordx4 v4, s[38:39] offset:3072 sc1
    s_add_u32 s36, s30, 1
    s_and_b32 s36, s36, 3
    s_lshl_b32 s36, s36, 12
    s_add_u32 s37, s36, s7
    s_and_b32 s37, s37, 0x7fff
    s_add_u32 m0, s5, s37
    s_add_u32 s36, s36, 2097152
    s_add_u32 s38, s54, s36
    s_addc_u32 s39, s55, 0
    s_waitcnt vmcnt(3)
    global_load_lds_dwordx4 v4, s[38:39] offset:0 sc1
    s_waitcnt vmcnt(3)
    global_load_lds_dwordx4 v4, s[38:39] offset:1024 sc1
    s_waitcnt vmcnt(3)
    global_load_lds_dwordx4 v4, s[38:39] offset:2048 sc1
    s_waitcnt vmcnt(3)
    global_load_lds_dwordx4 v4, s[38:39] offset:3072 sc1
    s_add_u32 s36, s30, 2
    s_and_b32 s36, s36, 3
    s_lshl_b32 s36, s36, 12
    s_add_u32 s37, s36, s7
    s_and_b32 s37, s37, 0x7fff
    s_add_u32 m0, s5, s37
    s_add_u32 s36, s36, 2097152
    s_add_u32 s38, s54, s36
    s_addc_u32 s39, s55, 0
    s_waitcnt vmcnt(3)
    global_load_lds_dwordx4 v4, s[38:39] offset:0 sc1
    s_waitcnt vmcnt(3)
    global_load_lds_dwordx4 v4, s[38:39] offset:1024 sc1
    s_waitcnt vmcnt(3)
    global_load_lds_dwordx4 v4, s[38:39] offset:2048 sc1
    s_waitcnt vmcnt(3)
    global_load_lds_dwordx4 v4, s[38:39] offset:3072 sc1
    s_add_u32 s36, s30, 3
    s_and_b32 s36, s36, 3
    s_lshl_b32 s36, s36, 12
    s_add_u32 s37, s36, s7
    s_and_b32 s37, s37, 0x7fff
    s_add_u32 m0, s5, s37
    s_add_u32 s36, s36, 2097152
    s_add_u32 s38, s54, s36
    s_addc_u32 s39, s55, 0
    s_waitcnt vmcnt(3)
    global_load_lds_dwordx4 v4, s[38:39] offset:0 sc1
    s_waitcnt vmcnt(3)
    global_load_lds_dwordx4 v4, s[38:39] offset:1024 sc1
    s_waitcnt vmcnt(3)
    global_load_lds_dwordx4 v4, s[38:39] offset:2048 sc1
    s_waitcnt vmcnt(3)
    global_load_lds_dwordx4 v4, s[38:39] offset:3072 sc1
    s_branch L_Bend
.p2align 12
L_Bend:
    s_add_u32 s36, s30, 0
    s_and_b32 s36, s36, 3
    s_lshl_b32 s36, s36, 12
    s_add_u32 s8, s54, s36
    s_addc_u32 s9, s55, 0
    s_add_u32 s36, s30, 1
    s_and_b32 s36, s36, 3
    s_lshl_b32 s36, s36, 12
    s_add_u32 s10, s54, s36
    s_addc_u32 s11, s55, 0
    s_add_u32 s36, s30, 2
    s_and_b32 s36, s36, 3
    s_lshl_b32 s36, s36, 12
    s_add_u32 s12, s54, s36
    s_addc_u32 s13, s55, 0
    s_add_u32 s36, s30, 3
    s_and_b32 s36, s36, 3
    s_lshl_b32 s36, s36, 12
    s_add_u32 s14, s54, s36
    s_addc_u32 s15, s55, 0
    s_mov_b32 s59, 15
    s_mov_b32 s45, 0
    v_add_u32 v21, -16, v6
    s_mul_i32 s36, s29, 5120
    s_add_u32 s36, s36, 131680
    s_add_u32 s40, s26, s36
    s_addc_u32 s41, s27, 0
    s_setprio 3
    s_waitcnt vmcnt(0) lgkmcnt(0)
    s_cmp_lg_u32 s52, 1
    s_cbranch_scc1 L_b_113
    s_mov_b32 s46, 0
L_sb_114:
    ds_read_b32 v20, v21 offset:0
    s_waitcnt lgkmcnt(0)
    v_cmp_gt_u32 vcc, 30, v20
    s_add_u32 s46, s46, 1
    s_cmp_eq_u64 vcc, 0
    s_cbranch_scc1 L_sbd_115
    s_sleep 1
    s_cmp_lt_u32 s46, 1600000
    s_cbranch_scc1 L_sb_114
L_sbd_115:
    s_mov_b32 s47, 1
    s_atomic_add s47, s[40:41], 0 glc
L_b_113:
    s_barrier
    s_lshl_b32 s36, s2, 2
    s_add_u32 s36, s36, s52
    s_cmp_lg_u32 s36, 0
    s_cbranch_scc1 L_b_116
    s_mov_b64 exec, 1
    global_store_dword v1, v7, s[26:27] offset:0 sc1
    s_mov_b64 exec, -1
L_b_116:
    v_mov_b64 v[96:97], 0
    v_mov_b64 v[98:99], 0
    v_mov_b64 v[100:101], 0
    v_mov_b64 v[102:103], 0
    v_mov_b64 v[104:105], 0
    v_mov_b64 v[106:107], 0
    v_mov_b64 v[108:109], 0
    v_mov_b64 v[110:111], 0
    v_mov_b64 v[112:113], 0
    v_mov_b64 v[114:115], 0
    v_mov_b64 v[116:117], 0
    v_mov_b64 v[118:119], 0
    v_mov_b64 v[120:121], 0
    v_mov_b64 v[122:123], 0
    v_mov_b64 v[124:125], 0
    v_mov_b64 v[126:127], 0
    v_and_b32 v22, 4, v0
    v_lshl_add_u32 v22, v22, 2, v21
    s_cmp_lg_u32 s52, 1
    s_cbranch_scc1 L_b_117
    s_waitcnt lgkmcnt(0)
    s_add_u32 s44, s47, 1
    s_mov_b32 s46, 0
L_cw_118:
    s_waitcnt lgkmcnt(0)
    s_cmp_ge_u32 s44, 8
    s_cbranch_scc1 L_cwd_119
    s_load_dword s44, s[40:41], 0 glc
    s_add_u32 s46, s46, 1
    s_cmp_lt_u32 s46, 200000
    s_cbranch_scc1 L_cw_118
    s_waitcnt lgkmcnt(0)
L_cwd_119:
L_b_117:
    s_mov_b32 s35, 38
    s_add_u32 s35, s35, 1
    v_mov_b32 v20, s35
    ds_write_b32 v5, v20
    v_mov_b32 v19, 40
    s_mov_b32 s46, 0
L_sb_120:
    ds_read_b32 v20, v22 offset:0
    s_waitcnt lgkmcnt(0)
    v_cmp_gt_u32 vcc, s35, v20
    s_add_u32 s46, s46, 1
    s_cmp_eq_u64 vcc, 0
    s_cbranch_scc1 L_sbd_121
    s_cmp_lt_u32 s46, 1600000
    s_cbranch_scc1 L_sb_120
L_sbd_121:
    s_mov_b32 s35, 40
    global_load_dwordx4 v[32:35], v4, s[8:9] offset:0 sc1
    global_load_dwordx4 v[36:39], v4, s[8:9] offset:1024 sc1
    global_load_dwordx4 v[40:43], v4, s[8:9] offset:2048 sc1
    global_load_dwordx4 v[44:47], v4, s[8:9] offset:3072 sc1
    global_load_dwordx4 v[48:51], v4, s[10:11] offset:0 sc1
    global_load_dwordx4 v[52:55], v4, s[10:11] offset:1024 sc1
    global_load_dwordx4 v[56:59], v4, s[10:11] offset:2048 sc1
    global_load_dwordx4 v[60:63], v4, s[10:11] offset:3072 sc1
    s_add_u32 s38, s56, 16384
    s_addc_u32 s39, s57, 0
    s_waitcnt vmcnt(4)
    v_max3_u32 v16, v32, v36, v40
    v_max_u32 v16, v16, v44
    v_cmp_eq_u32 vcc, -1, v16
    s_cmp_lg_u64 vcc, 0
    s_cbranch_scc1 L_miss
    s_bitset0_b32 s59, 0
    v_mfma_f32_32x32x16_bf16 v[96:111], v[128:131], v[32:35], v[96:111]
    global_load_dwordx4 v[64:67], v4, s[12:13] offset:0 sc1
    global_load_dwordx4 v[68:71], v4, s[12:13] offset:1024 sc1
    global_load_dwordx4 v[72:75], v4, s[12:13] offset:2048 sc1
    global_load_dwordx4 v[76:79], v4, s[12:13] offset:3072 sc1
    v_mfma_f32_32x32x16_bf16 v[112:127], v[132:135], v[32:35], v[112:127]
    v_mfma_f32_32x32x16_bf16 v[96:111], v[136:139], v[36:39], v[96:111]
    v_mfma_f32_32x32x16_bf16 v[112:127], v[140:143], v[36:39], v[112:127]
    v_mfma_f32_32x32x16_bf16 v[96:111], v[144:147], v[40:43], v[96:111]
    v_mfma_f32_32x32x16_bf16 v[112:127], v[148:151], v[40:43], v[112:127]
    v_mfma_f32_32x32x16_bf16 v[96:111], v[152:155], v[44:47], v[96:111]
    s_waitcnt vmcnt(4)
    v_max3_u32 v16, v48, v52, v56
    v_max_u32 v16, v16, v60
    v_cmp_eq_u32 vcc, -1, v16
    v_mfma_f32_32x32x16_bf16 v[112:127], v[156:159], v[44:47], v[112:127]
    s_cmp_lg_u64 vcc, 0
    s_cbranch_scc1 L_miss
    s_bitset0_b32 s59, 1
    v_mfma_f32_32x32x16_bf16 v[96:111], v[160:163], v[48:51], v[96:111]
    global_load_dwordx4 v[80:83], v4, s[14:15] offset:0 sc1
    global_load_dwordx4 v[84:87], v4, s[14:15] offset:1024 sc1
    global_load_dwordx4 v[88:91], v4, s[14:15] offset:2048 sc1
    global_load_dwordx4 v[92:95], v4, s[14:15] offset:3072 sc1
    ds_write_b32 v5, v19
    v_mfma_f32_32x32x16_bf16 v[112:127], v[164:167], v[48:51], v[112:127]
    v_mfma_f32_32x32x16_bf16 v[96:111], v[168:171], v[52:55], v[96:111]
    v_mfma_f32_32x32x16_bf16 v[112:127], v[172:175], v[52:55], v[112:127]
    v_mfma_f32_32x32x16_bf16 v[96:111], v[176:179], v[56:59], v[96:111]
    v_mfma_f32_32x32x16_bf16 v[112:127], v[180:183], v[56:59], v[112:127]
    v_mfma_f32_32x32x16_bf16 v[96:111], v[184:187], v[60:63], v[96:111]
    s_waitcnt vmcnt(4)
    v_max3_u32 v16, v64, v68, v72
    v_max_u32 v16, v16, v76
    v_cmp_eq_u32 vcc, -1, v16
    v_mfma_f32_32x32x16_bf16 v[112:127], v[188:191], v[60:63], v[112:127]
    s_cmp_lg_u64 vcc, 0
    s_cbranch_scc1 L_miss
    s_bitset0_b32 s59, 2
    v_mfma_f32_32x32x16_bf16 v[96:111], v[192:195], v[64:67], v[96:111]
    ds_read_b32 v20, v21
    v_mfma_f32_32x32x16_bf16 v[112:127], v[196:199], v[64:67], v[112:127]
    v_mfma_f32_32x32x16_bf16 v[96:111], v[200:203], v[68:71], v[96:111]
    v_mfma_f32_32x32x16_bf16 v[112:127], v[204:207], v[68:71], v[112:127]
    v_mfma_f32_32x32x16_bf16 v[96:111], v[208:211], v[72:75], v[96:111]
    v_mfma_f32_32x32x16_bf16 v[112:127], v[212:215], v[72:75], v[112:127]
    v_mfma_f32_32x32x16_bf16 v[96:111], v[216:219], v[76:79], v[96:111]
    s_waitcnt vmcnt(0)
    v_max3_u32 v16, v80, v84, v88
    v_max_u32 v16, v16, v92
    v_cmp_eq_u32 vcc, -1, v16
    v_mfma_f32_32x32x16_bf16 v[112:127], v[220:223], v[76:79], v[112:127]
    s_cmp_lg_u64 vcc, 0
    s_cbranch_scc1 L_miss
    s_bitset0_b32 s59, 3
    v_mfma_f32_32x32x16_bf16 v[96:111], v[224:227], v[80:83], v[96:111]
    v_mfma_f32_32x32x16_bf16 v[96:111], v[232:235], v[84:87], v[96:111]
    v_mfma_f32_32x32x16_bf16 v[96:111], v[240:243], v[88:91], v[96:111]
    v_mfma_f32_32x32x16_bf16 v[96:111], v[248:251], v[92:95], v[96:111]
    v_mfma_f32_32x32x16_bf16 v[112:127], v[228:231], v[80:83], v[112:127]
    s_waitcnt lgkmcnt(0)
    v_cmp_gt_u32 vcc, 40, v20
    s_cmp_eq_u64 vcc, 0
    s_cbranch_scc1 L_k_122
    s_mov_b32 s46, 0
L_sb_123:
    ds_read_b32 v20, v21 offset:0
    s_waitcnt lgkmcnt(0)
    v_cmp_gt_u32 vcc, 40, v20
    s_add_u32 s46, s46, 1
    s_cmp_eq_u64 vcc, 0
    s_cbranch_scc1 L_sbd_124
    s_cmp_lt_u32 s46, 1600000
    s_cbranch_scc1 L_sb_123
L_sbd_124:
L_k_122:
    v_mfma_f32_32x32x16_bf16 v[112:127], v[236:239], v[84:87], v[112:127]
    s_nop 5
    ds_write_b128 v9, v[96:99] offset:0
    v_mfma_f32_32x32x16_bf16 v[112:127], v[244:247], v[88:91], v[112:127]
    ds_write_b128 v14, v[100:103] offset:0
    v_mfma_f32_32x32x16_bf16 v[112:127], v[252:255], v[92:95], v[112:127]
    ds_write_b128 v15, v[104:107] offset:0
    ds_write_b128 v17, v[108:111] offset:0
    s_nop 9
L_gathered:
    ds_write_b128 v9, v[112:115] offset:128
    ds_write_b128 v14, v[116:119] offset:128
    ds_write_b128 v15, v[120:123] offset:128
    ds_write_b128 v17, v[124:127] offset:128
    s_waitcnt lgkmcnt(0)
    s_barrier
    ds_read_b128 v[32:35], v3 offset:0
    ds_read_b128 v[36:39], v24 offset:0
    ds_read_b128 v[40:43], v3 offset:8192
    ds_read_b128 v[44:47], v24 offset:8192
    ds_read_b128 v[48:51], v3 offset:2048
    ds_read_b128 v[52:55], v24 offset:2048
    ds_read_b128 v[56:59], v3 offset:10240
    ds_read_b128 v[60:63], v24 offset:10240
    s_waitcnt lgkmcnt(4)
    v_pk_add_f32 v[32:33], v[32:33], v[40:41]
    v_pk_add_f32 v[34:35], v[34:35], v[42:43]
    v_pk_add_f32 v[36:37], v[36:37], v[44:45]
    v_pk_add_f32 v[38:39], v[38:39], v[46:47]
    v_cvt_pk_bf16_f32 v64, v32, v33
    v_cvt_pk_bf16_f32 v65, v34, v35
    v_cvt_pk_bf16_f32 v66, v36, v37
    v_cvt_pk_bf16_f32 v67, v38, v39
    global_store_dwordx4 v2, v[64:67], s[56:57] sc1
    s_waitcnt lgkmcnt(0)
    v_pk_add_f32 v[48:49], v[48:49], v[56:57]
    v_pk_add_f32 v[50:51], v[50:51], v[58:59]
    v_pk_add_f32 v[52:53], v[52:53], v[60:61]
    v_pk_add_f32 v[54:55], v[54:55], v[62:63]
    v_cvt_pk_bf16_f32 v68, v48, v49
    v_cvt_pk_bf16_f32 v69, v50, v51
    v_cvt_pk_bf16_f32 v70, v52, v53
    v_cvt_pk_bf16_f32 v71, v54, v55
    global_store_dwordx4 v2, v[68:71], s[38:39] sc1
L_fin:
L_end:
    s_endpgm
L_check:
    s_mov_b32 s46, 0
L_sb_125:
    ds_read_b32 v50, v51 offset:0
    s_waitcnt lgkmcnt(0)
    v_cmp_gt_u32 vcc, s35, v50
    s_add_u32 s46, s46, 1
    s_cmp_eq_u64 vcc, 0
    s_cbranch_scc1 L_sbd_126
    s_sleep 1
    s_cmp_lt_u32 s46, 1600000
    s_cbranch_scc1 L_sb_125
L_sbd_126:
    s_branch L_checked
L_miss:
    ds_write_b32 v5, v19
    s_waitcnt vmcnt(0)
L_retry:
    s_sleep 2
    s_bitcmp1_b32 s59, 0
    s_cbranch_scc0 L_gs_127
    global_load_dwordx4 v[32:35], v4, s[8:9] offset:0 sc1
    global_load_dwordx4 v[36:39], v4, s[8:9] offset:1024 sc1
    global_load_dwordx4 v[40:43], v4, s[8:9] offset:2048 sc1
    global_load_dwordx4 v[44:47], v4, s[8:9] offset:3072 sc1
L_gs_127:
    s_bitcmp1_b32 s59, 1
    s_cbranch_scc0 L_gs_128
    global_load_dwordx4 v[48:51], v4, s[10:11] offset:0 sc1
    global_load_dwordx4 v[52:55], v4, s[10:11] offset:1024 sc1
    global_load_dwordx4 v[56:59], v4, s[10:11] offset:2048 sc1
    global_load_dwordx4 v[60:63], v4, s[10:11] offset:3072 sc1
L_gs_128:
    s_bitcmp1_b32 s59, 2
    s_cbranch_scc0 L_gs_129
    global_load_dwordx4 v[64:67], v4, s[12:13] offset:0 sc1
    global_load_dwordx4 v[68:71], v4, s[12:13] offset:1024 sc1
    global_load_dwordx4 v[72:75], v4, s[12:13] offset:2048 sc1
    global_load_dwordx4 v[76:79], v4, s[12:13] offset:3072 sc1
L_gs_129:
    s_bitcmp1_b32 s59, 3
    s_cbranch_scc0 L_gs_130
    global_load_dwordx4 v[80:83], v4, s[14:15] offset:0 sc1
    global_load_dwordx4 v[84:87], v4, s[14:15] offset:1024 sc1
    global_load_dwordx4 v[88:91], v4, s[14:15] offset:2048 sc1
    global_load_dwordx4 v[92:95], v4, s[14:15] offset:3072 sc1
L_gs_130:
    s_waitcnt vmcnt(0)
    s_bitcmp1_b32 s59, 0
    s_cbranch_scc0 L_cs_131
    v_max3_u32 v16, v32, v36, v40
    v_max_u32 v16, v16, v44
    v_cmp_eq_u32 vcc, -1, v16
    s_cmp_lg_u64 vcc, 0
    s_cbranch_scc1 L_cs_131
    s_bitset0_b32 s59, 0
    v_mfma_f32_32x32x16_bf16 v[96:111], v[128:131], v[32:35], v[96:111]
    v_mfma_f32_32x32x16_bf16 v[112:127], v[132:135], v[32:35], v[112:127]
    v_mfma_f32_32x32x16_bf16 v[96:111], v[136:139], v[36:39], v[96:111]
    v_mfma_f32_32x32x16_bf16 v[112:127], v[140:143], v[36:39], v[112:127]
    v_mfma_f32_32x32x16_bf16 v[96:111], v[144:147], v[40:43], v[96:111]
    v_mfma_f32_32x32x16_bf16 v[112:127], v[148:151], v[40:43], v[112:127]
    v_mfma_f32_32x32x16_bf16 v[96:111], v[152:155], v[44:47], v[96:111]
    v_mfma_f32_32x32x16_bf16 v[112:127], v[156:159], v[44:47], v[112:127]
L_cs_131:
    s_bitcmp1_b32 s59, 1
    s_cbranch_scc0 L_cs_132
    v_max3_u32 v16, v48, v52, v56
    v_max_u32 v16, v16, v60
    v_cmp_eq_u32 vcc, -1, v16
    s_cmp_lg_u64 vcc, 0
    s_cbranch_scc1 L_cs_132
    s_bitset0_b32 s59, 1
    v_mfma_f32_32x32x16_bf16 v[96:111], v[160:163], v[48:51], v[96:111]
    v_mfma_f32_32x32x16_bf16 v[112:127], v[164:167], v[48:51], v[112:127]
    v_mfma_f32_32x32x16_bf16 v[96:111], v[168:171], v[52:55], v[96:111]
    v_mfma_f32_32x32x16_bf16 v[112:127], v[172:175], v[52:55], v[112:127]
    v_mfma_f32_32x32x16_bf16 v[96:111], v[176:179], v[56:59], v[96:111]
    v_mfma_f32_32x32x16_bf16 v[112:127], v[180:183], v[56:59], v[112:127]
    v_mfma_f32_32x32x16_bf16 v[96:111], v[184:187], v[60:63], v[96:111]
    v_mfma_f32_32x32x16_bf16 v[112:127], v[188:191], v[60:63], v[112:127]
L_cs_132:
    s_bitcmp1_b32 s59, 2
    s_cbranch_scc0 L_cs_133
    v_max3_u32 v16, v64, v68, v72
    v_max_u32 v16, v16, v76
    v_cmp_eq_u32 vcc, -1, v16
    s_cmp_lg_u64 vcc, 0
    s_cbranch_scc1 L_cs_133
    s_bitset0_b32 s59, 2
    v_mfma_f32_32x32x16_bf16 v[96:111], v[192:195], v[64:67], v[96:111]
    v_mfma_f32_32x32x16_bf16 v[112:127], v[196:199], v[64:67], v[112:127]
    v_mfma_f32_32x32x16_bf16 v[96:111], v[200:203], v[68:71], v[96:111]
    v_mfma_f32_32x32x16_bf16 v[112:127], v[204:207], v[68:71], v[112:127]
    v_mfma_f32_32x32x16_bf16 v[96:111], v[208:211], v[72:75], v[96:111]
    v_mfma_f32_32x32x16_bf16 v[112:127], v[212:215], v[72:75], v[112:127]
    v_mfma_f32_32x32x16_bf16 v[96:111], v[216:219], v[76:79], v[96:111]
    v_mfma_f32_32x32x16_bf16 v[112:127], v[220:223], v[76:79], v[112:127]
L_cs_133:
    s_bitcmp1_b32 s59, 3
    s_cbranch_scc0 L_cs_134
    v_max3_u32 v16, v80, v84, v88
    v_max_u32 v16, v16, v92
    v_cmp_eq_u32 vcc, -1, v16
    s_cmp_lg_u64 vcc, 0
    s_cbranch_scc1 L_cs_134
    s_bitset0_b32 s59, 3
    v_mfma_f32_32x32x16_bf16 v[96:111], v[224:227], v[80:83], v[96:111]
    v_mfma_f32_32x32x16_bf16 v[112:127], v[228:231], v[80:83], v[112:127]
    v_mfma_f32_32x32x16_bf16 v[96:111], v[232:235], v[84:87], v[96:111]
    v_mfma_f32_32x32x16_bf16 v[112:127], v[236:239], v[84:87], v[112:127]
    v_mfma_f32_32x32x16_bf16 v[96:111], v[240:243], v[88:91], v[96:111]
    v_mfma_f32_32x32x16_bf16 v[112:127], v[244:247], v[88:91], v[112:127]
    v_mfma_f32_32x32x16_bf16 v[96:111], v[248:251], v[92:95], v[96:111]
    v_mfma_f32_32x32x16_bf16 v[112:127], v[252:255], v[92:95], v[112:127]
L_cs_134:
    s_add_u32 s45, s45, 1
    s_cmp_eq_u32 s59, 0
    s_cbranch_scc1 L_rdone
    s_cmp_lt_u32 s45, 200000
    s_cbranch_scc1 L_retry
L_rdone:
    s_mov_b32 s46, 0
L_sb_135:
    ds_read_b32 v20, v21 offset:0
    s_waitcnt lgkmcnt(0)
    v_cmp_gt_u32 vcc, 40, v20
    s_add_u32 s46, s46, 1
    s_cmp_eq_u64 vcc, 0
    s_cbranch_scc1 L_sbd_136
    s_cmp_lt_u32 s46, 1600000
    s_cbranch_scc1 L_sb_135
L_sbd_136:
    s_nop 3
    ds_write_b128 v9, v[96:99] offset:0
    ds_write_b128 v14, v[100:103] offset:0
    ds_write_b128 v15, v[104:107] offset:0
    ds_write_b128 v17, v[108:111] offset:0
    s_branch L_gathered
L_last:
L_fallback:
    v_mov_b32 v212, 0xff800000
    v_mov_b32 v213, 0xff800000
    s_add_u32 s36, s26, 131072
    s_addc_u32 s37, s27, 0
    s_mov_b32 s7, 64
L_fb_137:
    global_load_dwordx4 v[192:195], v11, s[36:37] sc1
    s_add_u32 s36, s36, 2560
    s_addc_u32 s37, s37, 0
    s_waitcnt vmcnt(0)
    v_mfma_f32_32x32x16_bf16 v[128:143], v[192:195], v[24:27], 0
    v_mfma_f32_32x32x16_bf16 v[144:159], v[192:195], v[28:31], 0
    s_nop 7
    s_nop 4
    v_max3_f32 v212, v128, v129, v212
    v_max3_f32 v212, v130, v131, v212
    v_max3_f32 v212, v132, v133, v212
    v_max3_f32 v212, v134, v135, v212
    v_max3_f32 v212, v136, v137, v212
    v_max3_f32 v212, v138, v139, v212
    v_max3_f32 v212, v140, v141, v212
    v_max3_f32 v212, v142, v143, v212
    v_max3_f32 v213, v144, v145, v213
    v_max3_f32 v213, v146, v147, v213
    v_max3_f32 v213, v148, v149, v213
    v_max3_f32 v213, v150, v151, v213
    v_max3_f32 v213, v152, v153, v213
    v_max3_f32 v213, v154, v155, v213
    v_max3_f32 v213, v156, v157, v213
    v_max3_f32 v213, v158, v159, v213
    s_sub_u32 s7, s7, 1
    s_cmp_lg_u32 s7, 0
    s_cbranch_scc1 L_fb_137
    v_mov_b32 v214, v212
    s_nop 1
    v_permlane32_swap_b32 v212, v214
    s_nop 1
    v_max_f32 v212, v212, v214
    v_sub_f32 v160, 0, v212
    v_sub_f32 v161, 0, v212
    v_sub_f32 v162, 0, v212
    v_sub_f32 v163, 0, v212
    v_sub_f32 v164, 0, v212
    v_sub_f32 v165, 0, v212
    v_sub_f32 v166, 0, v212
    v_sub_f32 v167, 0, v212
    v_sub_f32 v168, 0, v212
    v_sub_f32 v169, 0, v212
    v_sub_f32 v170, 0, v212
    v_sub_f32 v171, 0, v212
    v_sub_f32 v172, 0, v212
    v_sub_f32 v173, 0, v212
    v_sub_f32 v174, 0, v212
    v_sub_f32 v175, 0, v212
    v_mov_b32 v214, v213
    s_nop 1
    v_permlane32_swap_b32 v213, v214
    s_nop 1
    v_max_f32 v213, v213, v214
    v_sub_f32 v176, 0, v213
    v_sub_f32 v177, 0, v213
    v_sub_f32 v178, 0, v213
    v_sub_f32 v179, 0, v213
    v_sub_f32 v180, 0, v213
    v_sub_f32 v181, 0, v213
    v_sub_f32 v182, 0, v213
    v_sub_f32 v183, 0, v213
    v_sub_f32 v184, 0, v213
    v_sub_f32 v185, 0, v213
    v_sub_f32 v186, 0, v213
    v_sub_f32 v187, 0, v213
    v_sub_f32 v188, 0, v213
    v_sub_f32 v189, 0, v213
    v_sub_f32 v190, 0, v213
    v_sub_f32 v191, 0, v213
    v_mov_b32 v96, 0
    v_mov_b32 v97, 0
    v_mov_b32 v98, 0
    v_mov_b32 v99, 0
    v_mov_b32 v100, 0
    v_mov_b32 v101, 0
    v_mov_b32 v102, 0
    v_mov_b32 v103, 0
    v_mov_b32 v104, 0
    v_mov_b32 v105, 0
    v_mov_b32 v106, 0
    v_mov_b32 v107, 0
    v_mov_b32 v108, 0
    v_mov_b32 v109, 0
    v_mov_b32 v110, 0
    v_mov_b32 v111, 0
    v_mov_b32 v112, 0
    v_mov_b32 v113, 0
    v_mov_b32 v114, 0
    v_mov_b32 v115, 0
    v_mov_b32 v116, 0
    v_mov_b32 v117, 0
    v_mov_b32 v118, 0
    v_mov_b32 v119, 0
    v_mov_b32 v120, 0
    v_mov_b32 v121, 0
    v_mov_b32 v122, 0
    v_mov_b32 v123, 0
    v_mov_b32 v124, 0
    v_mov_b32 v125, 0
    v_mov_b32 v126, 0
    v_mov_b32 v127, 0
    s_add_u32 s36, s26, 131072
    s_addc_u32 s37, s27, 0
    s_mov_b32 s7, 64
L_fb_138:
    global_load_dwordx4 v[192:195], v11, s[36:37] sc1
    global_load_dwordx4 v[196:199], v12, s[36:37] offset:640 sc1
    global_load_dwordx4 v[200:203], v12, s[36:37] offset:1920 sc1
    s_add_u32 s36, s36, 2560
    s_addc_u32 s37, s37, 0
    s_waitcnt vmcnt(0)
    v_mfma_f32_32x32x16_bf16 v[128:143], v[192:195], v[24:27], v[160:175]
    v_mfma_f32_32x32x16_bf16 v[144:159], v[192:195], v[28:31], v[176:191]
    s_nop 7
    s_nop 4
    v_exp_f32 v128, v128
    v_exp_f32 v129, v129
    v_exp_f32 v130, v130
    v_exp_f32 v131, v131
    v_exp_f32 v132, v132
    v_exp_f32 v133, v133
    v_exp_f32 v134, v134
    v_exp_f32 v135, v135
    v_exp_f32 v136, v136
    v_exp_f32 v137, v137
    v_exp_f32 v138, v138
    v_exp_f32 v139, v139
    v_exp_f32 v140, v140
    v_exp_f32 v141, v141
    v_exp_f32 v142, v142
    v_exp_f32 v143, v143
    s_nop 1
    v_smfmac_f32_32x32x32_bf16 v[96:111], v[196:199], v[128:135], v10
    v_smfmac_f32_32x32x32_bf16 v[96:111], v[200:203], v[136:143], v10
    v_exp_f32 v144, v144
    v_exp_f32 v145, v145
    v_exp_f32 v146, v146
    v_exp_f32 v147, v147
    v_exp_f32 v148, v148
    v_exp_f32 v149, v149
    v_exp_f32 v150, v150
    v_exp_f32 v151, v151
    v_exp_f32 v152, v152
    v_exp_f32 v153, v153
    v_exp_f32 v154, v154
    v_exp_f32 v155, v155
    v_exp_f32 v156, v156
    v_exp_f32 v157, v157
    v_exp_f32 v158, v158
    v_exp_f32 v159, v159
    s_nop 1
    v_smfmac_f32_32x32x32_bf16 v[112:127], v[196:199], v[144:151], v10
    v_smfmac_f32_32x32x32_bf16 v[112:127], v[200:203], v[152:159], v10
    s_sub_u32 s7, s7, 1
    s_cmp_lg_u32 s7, 0
    s_cbranch_scc1 L_fb_138
    s_nop 7
    s_nop 4
    s_branch L_norm
.section .rodata,"a"
.p2align 6
.amdhsa_kernel concat_heads__grouped_kv_mqa__linear_attn_block__prompt_kernel
  .amdhsa_next_free_vgpr 256
  .amdhsa_next_free_sgpr 102
  .amdhsa_accum_offset 256
  .amdhsa_group_segment_fixed_size 0
  .amdhsa_kernarg_size 88
  .amdhsa_user_sgpr_count 2
  .amdhsa_user_sgpr_kernarg_segment_ptr 1
  .amdhsa_system_sgpr_workgroup_id_x 1
  .amdhsa_dx10_clamp 0
.end_amdhsa_kernel
```
